```python
import torch

def _softmax(x, axis=-1):
    return torch.softmax(x, dim=axis)
def _gelu(x):
    return torch.nn.functional.gelu(x, approximate="tanh")
def _silu(x):
    return torch.nn.functional.silu(x)
def _sigmoid(x):
    return torch.sigmoid(x)
def _layernorm(x, axis=-1, eps=1e-5):
    m = x.mean(dim=axis, keepdim=True)
    v = x.var(dim=axis, keepdim=True, unbiased=False)
    return (x - m) / torch.sqrt(v + eps)
def _scatter_add(tgt, idx, src, axis=0):
    return tgt.clone().index_add_(axis, idx, src)
def _segment_sum(src, seg, n):
    out = torch.zeros((n,) + src.shape[1:], dtype=src.dtype)
    return out.index_add_(0, seg, src)
def _pad(x, pw):
    flat = tuple(v for pair in reversed(pw) for v in pair)
    return torch.nn.functional.pad(x, flat)

kernel_name = 'standalone__paged_block_table_kv_radixattention__decode'

def setup_inputs():

    _w = (lambda a: (lambda t: t.to(torch.bfloat16) if t.is_floating_point() else t)(torch.as_tensor(a)))
    B, H, Hkv, Dh = 8, 32, 8, 128
    Lk = 4096
    bs = 16
    nb = max(2, Lk // bs)
    P = max(1, nb // 2)
    n_phys = P + B * (nb - P)
    shared = torch.arange(P, dtype=torch.int64)
    priv = P + torch.arange(B * (nb - P), dtype=torch.int64).reshape(B, nb - P)
    bt = torch.cat([torch.tile(shared[None, :], (B, 1)), priv], dim=1)
    ctx = nb * bs - (torch.arange(1, B + 1, dtype=torch.int64) * 2654435761) % max(1, (nb * bs - P * bs) // 2)
    return {
        "q": _w((lambda *s: torch.randn(*s, dtype=torch.bfloat16) * 0.8)(B, H, Dh)),
        "k_cache": _w((lambda *s: torch.randn(*s, dtype=torch.bfloat16) * 0.8)(n_phys, bs, Hkv, Dh)),
        "v_cache": _w((lambda *s: torch.randn(*s, dtype=torch.bfloat16) * 0.05)(n_phys, bs, Hkv, Dh)),
        "block_table": _w(bt.to(torch.int64)),
        "ctx_lens": _w(torch.as_tensor(ctx).to(torch.int64)),
    }

def reference(q, k_cache, v_cache, block_table, ctx_lens):
    B, H, Dh = q.shape
    n_phys, bs, Hkv, _ = k_cache.shape
    nb = block_table.shape[1]
    Lk = nb * bs
    rep = H // Hkv
    k = k_cache[block_table].reshape(B, Lk, Hkv, Dh)
    v = v_cache[block_table].reshape(B, Lk, Hkv, Dh)
    k = (lambda x, n, axis: torch.repeat_interleave(x, n, dim=axis))(k, rep, axis=2)
    v = (lambda x, n, axis: torch.repeat_interleave(x, n, dim=axis))(v, rep, axis=2)
    scores = torch.einsum("bhd,bkhd->bhk", q, k) * (Dh ** -0.5)
    pos = torch.arange(Lk)
    valid = pos[None, :] < ctx_lens[:, None]
    scores = torch.where(valid[:, None, :], scores, -1e9)
    p = _softmax(scores, axis=-1)
    return torch.einsum("bhk,bkhd->bhd", p, v)
```

```asm
; @launch grid=(256,1,1) block=(512,1,1) lds=157824
.amdgcn_target "amdgcn-amd-amdhsa--gfx950"
.text
.globl standalone__paged_block_table_kv_radixattention__decode_kernel
.p2align 8
.type standalone__paged_block_table_kv_radixattention__decode_kernel,@function
standalone__paged_block_table_kv_radixattention__decode_kernel:
  s_cmp_ge_u32 s2, 256
  s_cbranch_scc1 A_END
  s_load_dwordx16 s[8:23], s[0:1], 0
  s_setprio 3
  v_and_b32 v1, 63, v0
  v_lshrrev_b32 v2, 6, v0
  v_lshlrev_b32 v3, 4, v1
  v_readfirstlane_b32 s3, v2
  v_lshlrev_b32 v4, 4, v0
  v_lshrrev_b32 v6, 4, v1
  v_and_b32 v7, 15, v1
  s_and_b32 s42, s2, 127
  s_lshr_b32 s43, s2, 7
  s_lshl_b32 s43, s43, 2
  s_mov_b32 s68, 0
  s_mov_b32 s69, 0
  s_mov_b32 s48, 29
  s_mov_b32 s100, 2260
  s_cmp_ge_u32 s42, 29
  s_cselect_b32 s69, 1, s69
  s_cselect_b32 s68, 29, s68
  s_cselect_b32 s48, 41, s48
  s_cselect_b32 s100, 1599, s100
  s_cmp_ge_u32 s42, 70
  s_cselect_b32 s69, 2, s69
  s_cselect_b32 s68, 70, s68
  s_cselect_b32 s48, 28, s48
  s_cselect_b32 s100, 2341, s100
  s_cmp_ge_u32 s42, 98
  s_cselect_b32 s69, 3, s69
  s_cselect_b32 s68, 98, s68
  s_cselect_b32 s48, 30, s48
  s_cselect_b32 s100, 2185, s100
  s_sub_u32 s42, s42, s68
  s_add_u32 s43, s43, s69
  s_sub_u32 s101, s42, 8
  s_and_b32 s68, s3, 3
  s_lshl_b32 s68, s68, 2
  v_add_u32 v2, s68, v6
  v_xor_b32 v2, v2, v7
  v_lshlrev_b32 v2, 4, v2
  v_lshl_add_u32 v42, v6, 8, v2
  s_lshl_b32 s82, s43, 8
  s_lshl_b32 s84, s3, 13
  s_lshl_b32 s68, s43, 10
  s_add_u32 s84, s84, s68
  s_lshl_b32 s83, s3, 10
  s_add_u32 s83, s83, 0x23000
  s_lshl_b32 s81, s3, 14
  v_add_u32 v2, 0, v6
  v_xor_b32 v5, v2, v7
  v_lshlrev_b32 v5, 4, v5
  v_lshl_add_u32 v16, v2, 11, v5
  v_lshl_add_u32 v28, v7, 8, v5
  v_add_u32 v2, 4, v6
  v_xor_b32 v5, v2, v7
  v_lshlrev_b32 v5, 4, v5
  v_lshl_add_u32 v17, v2, 11, v5
  v_subrev_u32 v17, 1024, v17
  v_lshl_add_u32 v29, v7, 8, v5
  v_add_u32 v2, 8, v6
  v_xor_b32 v5, v2, v7
  v_lshlrev_b32 v5, 4, v5
  v_lshl_add_u32 v18, v2, 11, v5
  v_subrev_u32 v18, 2048, v18
  v_lshl_add_u32 v30, v7, 8, v5
  v_add_u32 v2, 12, v6
  v_xor_b32 v5, v2, v7
  v_lshlrev_b32 v5, 4, v5
  v_lshl_add_u32 v19, v2, 11, v5
  v_subrev_u32 v19, 3072, v19
  v_lshl_add_u32 v31, v7, 8, v5
  s_cmp_ge_u32 s3, 4
  s_cbranch_scc1 A_NOPRED
  s_add_u32 s68, s48, 883
  s_mul_i32 s68, s68, s100
  s_lshr_b32 s68, s68, 16
  s_max_u32 s68, s68, 20
  s_min_u32 s68, s68, 32
  s_mul_i32 s70, s42, s68
  s_add_u32 s68, s70, s68
  s_min_u32 s68, s68, 884
  s_add_u32 s70, s70, s3
  v_lshl_add_u32 v52, v1, 3, s70
  v_mov_b32 v53, v52
  v_subrev_u32 v54, 228, v52
  v_med3_i32 v54, v54, 0, 1
  v_mad_u32_u24 v53, v54, 27, v53
  v_subrev_u32 v54, 302, v52
  v_med3_i32 v54, v54, 0, 1
  v_mad_u32_u24 v53, v54, 54, v53
  v_subrev_u32 v54, 413, v52
  v_med3_i32 v54, v54, 0, 1
  v_mad_u32_u24 v53, v54, 17, v53
  v_subrev_u32 v54, 497, v52
  v_med3_i32 v54, v54, 0, 1
  v_mad_u32_u24 v53, v54, 44, v53
  v_subrev_u32 v54, 618, v52
  v_med3_i32 v54, v54, 0, 1
  v_mad_u32_u24 v53, v54, 7, v53
  v_subrev_u32 v54, 712, v52
  v_med3_i32 v54, v54, 0, 1
  v_mad_u32_u24 v53, v54, 34, v53
  v_subrev_u32 v54, 779, v52
  v_med3_i32 v54, v54, 0, 1
  v_mad_u32_u24 v53, v54, 61, v53
  v_lshl_add_u32 v53, v53, 15, s82
  v_cmp_gt_u32 vcc, s68, v52
  v_mov_b32 v54, 0x80000000
  s_nop 0
  v_cndmask_b32 v53, v54, v53, vcc
  s_nop 0
  v_readlane_b32 s64, v53, 0
  v_readlane_b32 s65, v53, 1
  v_readlane_b32 s66, v53, 2
  v_readlane_b32 s67, v53, 3
A_NOPRED:
  s_lshl_b32 s69, s3, 2
  s_waitcnt lgkmcnt(0)
  global_load_dwordx4 v[8:11], v4, s[14:15]
  global_load_dwordx4 v[12:15], v3, s[14:15]
  s_load_dword s40, s[16:17], s69
  s_mov_b32 s32, s8
  s_and_b32 s33, s9, 0xffff
  s_mov_b32 s34, 0x10000
  s_mov_b32 s35, 0x20000
  s_mov_b32 m0, s83
  s_mov_b32 s24, s10
  s_and_b32 s25, s11, 0xffff
  s_mov_b32 s26, 0x2400000
  s_mov_b32 s27, 0x20000
  buffer_load_dwordx4 v42, s[32:35], s84 offen lds
  s_barrier
  s_cmp_ge_u32 s3, 4
  s_cbranch_scc1 A_NOSPEC
  s_add_u32 m0, s81, 0
  s_nop 0
  buffer_load_dwordx4 v16, s[24:27], s64 offen offset:0 nt lds
  buffer_load_dwordx4 v17, s[24:27], s64 offen offset:1024 nt lds
  buffer_load_dwordx4 v18, s[24:27], s64 offen offset:2048 nt lds
  buffer_load_dwordx4 v19, s[24:27], s64 offen offset:3072 nt lds
  s_add_u32 m0, s81, 4096
  s_nop 0
  buffer_load_dwordx4 v16, s[24:27], s65 offen offset:0 nt lds
  buffer_load_dwordx4 v17, s[24:27], s65 offen offset:1024 nt lds
  buffer_load_dwordx4 v18, s[24:27], s65 offen offset:2048 nt lds
  buffer_load_dwordx4 v19, s[24:27], s65 offen offset:3072 nt lds
A_NOSPEC:
  s_mov_b32 s28, s12
  s_and_b32 s29, s13, 0xffff
  s_mov_b32 s30, 0x2400000
  s_mov_b32 s31, 0x20000
  s_mov_b32 s36, s22
  s_and_b32 s37, s23, 0xffff
  s_mov_b32 s38, 0x800000
  s_mov_b32 s39, 0x20000
  s_mov_b32 s80, 0x3e0293ee
  s_mov_b32 s4, 0x00010001
  s_mov_b32 s5, 0x00010001
  s_mov_b32 s6, 0x01ff01ff
  s_mov_b32 s7, 0x01ff01ff
  v_mov_b32 v46, 0xf1800000
  v_mov_b32 v198, 0
  s_movk_i32 s87, 0xff
  s_cmp_lg_u32 s2, 28
  s_cbranch_scc1 A_NOEP
  s_cmp_lg_u32 s3, 7
  s_cbranch_scc1 A_NOEP
  s_mov_b32 s68, 0x410000
  buffer_load_dword v197, v198, s[36:39], s68 offen sc1
  s_waitcnt vmcnt(0)
  v_add_u32 v197, 1, v197
  v_max_u32 v197, 1, v197
  s_mov_b64 exec, 1
  buffer_store_dword v197, v198, s[36:39], s68 offen sc1
  global_store_dword v198, v197, s[20:21] sc0 sc1
  s_mov_b64 exec, -1
A_NOEP:
  v_add_u32 v2, 0, v6
  v_and_b32 v5, 7, v2
  v_lshlrev_b32 v5, 1, v5
  v_xor_b32 v5, v5, v7
  v_lshlrev_b32 v5, 4, v5
  v_lshl_add_u32 v20, v2, 11, v5
  v_add_u32 v2, 4, v6
  v_and_b32 v5, 7, v2
  v_lshlrev_b32 v5, 1, v5
  v_xor_b32 v5, v5, v7
  v_lshlrev_b32 v5, 4, v5
  v_lshl_add_u32 v21, v2, 11, v5
  v_subrev_u32 v21, 1024, v21
  v_add_u32 v2, 8, v6
  v_and_b32 v5, 7, v2
  v_lshlrev_b32 v5, 1, v5
  v_xor_b32 v5, v5, v7
  v_lshlrev_b32 v5, 4, v5
  v_lshl_add_u32 v22, v2, 11, v5
  v_subrev_u32 v22, 2048, v22
  v_add_u32 v2, 12, v6
  v_and_b32 v5, 7, v2
  v_lshlrev_b32 v5, 1, v5
  v_xor_b32 v5, v5, v7
  v_lshlrev_b32 v5, 4, v5
  v_lshl_add_u32 v23, v2, 11, v5
  v_subrev_u32 v23, 3072, v23
  v_add_u32 v24, s81, v28
  v_add_u32 v28, 0x23000, v28
  v_add_u32 v25, s81, v29
  v_add_u32 v29, 0x23000, v29
  v_add_u32 v26, s81, v30
  v_add_u32 v30, 0x23000, v30
  v_add_u32 v27, s81, v31
  v_add_u32 v31, 0x23000, v31
  v_lshrrev_b32 v47, 2, v7
  v_lshl_add_u32 v2, v6, 2, v47
  v_and_b32 v5, 7, v2
  v_xor_b32 v5, s3, v5
  v_lshlrev_b32 v5, 5, v5
  v_lshl_add_u32 v5, v2, 8, v5
  v_and_b32 v2, 3, v7
  v_lshl_add_u32 v32, v2, 3, v5
  v_add_u32 v33, 0x10000, v32
  v_add_u32 v34, 0x20000, v3
  s_lshr_b32 s68, s3, 1
  s_lshl_b32 s68, s68, 10
  s_and_b32 s69, s3, 1
  s_lshl_b32 s69, s69, 3
  s_add_u32 s68, s68, s69
  v_add_u32 v35, s68, v34
  v_lshlrev_b32 v36, 5, v7
  v_add_u32 v36, 0x26000, v36
  v_lshl_add_u32 v38, v6, 2, 0
  v_lshl_add_u32 v39, v6, 2, 1
  v_lshl_add_u32 v40, v6, 2, 2
  v_lshl_add_u32 v41, v6, 2, 3
  v_lshlrev_b32 v2, 19, v6
  v_lshl_add_u32 v43, v7, 4, v2
  v_lshlrev_b32 v2, 13, v47
  v_and_b32 v5, 3, v7
  v_lshl_add_u32 v44, v5, 8, v2
  v_add_u32 v2, -1, v7
  v_and_b32 v5, 7, v2
  v_lshlrev_b32 v5, 2, v5
  v_add_u32 v45, 0x22020, v5
  v_max_i32 v2, 0, v2
  v_min_u32 v2, 7, v2
  v_lshlrev_b32 v2, 10, v2
  v_add_u32 v37, 0x20000, v2
  s_waitcnt lgkmcnt(0)
  s_max_i32 s40, s40, 0
  s_min_i32 s40, s40, 4096
  s_mov_b32 s85, 0
  v_mov_b32 v199, 0x26840
  s_lshl_b32 s68, s3, 2
  v_add_u32 v2, s68, v199
  ds_write2_b32 v2, v198, v198 offset0:0 offset1:8
A_ROUND:
  s_add_u32 s85, s85, 1
  v_lshlrev_b32 v2, 4, v0
  v_add_u32 v2, 0x20000, v2
  s_lshl_b32 s68, s3, 2
  s_add_u32 s68, s68, 0x22000
  v_mov_b32 v5, s68
  v_mov_b32 v53, s40
  s_lshr_b32 s69, s40, 4
  v_mov_b32 v4, 0x22000
  s_cmp_eq_u32 s85, 1
  s_cselect_b32 s70, 4, 0
  s_cmp_lt_u32 s3, s70
  s_cbranch_scc1 A_W16
  s_waitcnt vmcnt(0)
  s_branch A_WD
A_W16:
  s_waitcnt vmcnt(8)
A_WD:
  v_cmp_ne_u32 s[72:73], v8, v12
  v_cmp_ne_u32 s[74:75], v9, v13
  v_cmp_ne_u32 s[76:77], v10, v14
  v_cmp_ne_u32 s[78:79], v11, v15
  ds_write_b128 v2, v[8:11]
  s_or_b64 s[72:73], s[72:73], s[74:75]
  s_or_b64 s[76:77], s[76:77], s[78:79]
  s_or_b64 s[72:73], s[72:73], s[76:77]
  s_ff1_i32_b64 s68, s[72:73]
  s_lshl_b32 s68, s68, 2
  s_min_u32 s68, s68, s69
  v_mov_b32 v52, s68
  ds_write2_b32 v5, v52, v53 offset0:0 offset1:8
  s_waitcnt lgkmcnt(0)
  s_barrier
  s_cmp_eq_u32 s85, 1
  s_cselect_b32 s68, 4, 0
  s_cmp_lt_u32 s3, s68
  s_cbranch_scc0 A_NOSPEC2
  s_add_u32 m0, s81, 8192
  s_nop 0
  buffer_load_dwordx4 v16, s[24:27], s66 offen offset:0 nt lds
  buffer_load_dwordx4 v17, s[24:27], s66 offen offset:1024 nt lds
  buffer_load_dwordx4 v18, s[24:27], s66 offen offset:2048 nt lds
  buffer_load_dwordx4 v19, s[24:27], s66 offen offset:3072 nt lds
  s_add_u32 m0, s81, 12288
  s_nop 0
  buffer_load_dwordx4 v16, s[24:27], s67 offen offset:0 nt lds
  buffer_load_dwordx4 v17, s[24:27], s67 offen offset:1024 nt lds
  buffer_load_dwordx4 v18, s[24:27], s67 offen offset:2048 nt lds
  buffer_load_dwordx4 v19, s[24:27], s67 offen offset:3072 nt lds
A_NOSPEC2:
  ds_read_b128 v[52:55], v4
  ds_read_b128 v[56:59], v4 offset:16
  ds_read_b32 v216, v45
  s_waitcnt lgkmcnt(0)
  v_min3_u32 v52, v52, v53, v54
  v_min3_u32 v55, v55, v56, v57
  v_add_u32 v218, 15, v216
  v_min3_u32 v52, v52, v58, v59
  v_lshrrev_b32 v218, 4, v218
  v_min_u32 v217, v52, v55
  v_sub_u32 v218, v218, v217
  v_cndmask_b32 v218, v218, v217, s[4:5]
  v_cndmask_b32 v218, 0, v218, s[6:7]
  v_mov_b32 v219, v218
  v_cndmask_b32 v60, v217, 0, s[4:5]
  v_readfirstlane_b32 s41, v217
  v_add_u32_dpp v219, v219, v219 row_shr:1 row_mask:0xf bank_mask:0xf bound_ctrl:0
  v_lshlrev_b32 v61, 3, v6
  v_add_u32 v61, s3, v61
  v_add_u32_dpp v219, v219, v219 row_shr:2 row_mask:0xf bank_mask:0xf bound_ctrl:0
  s_nop 1
  v_add_u32_dpp v219, v219, v219 row_shr:4 row_mask:0xf bank_mask:0xf bound_ctrl:0
  s_nop 1
  v_add_u32_dpp v219, v219, v219 row_shr:8 row_mask:0xf bank_mask:0xf bound_ctrl:0
  s_nop 0
  v_readlane_b32 s44, v219, 8
  v_sub_u32 v220, v219, v218
  v_sub_u32 v60, v220, v60
  s_add_u32 s45, s44, s48
  s_sub_u32 s45, s45, 1
  s_mul_i32 s45, s45, s100
  s_lshr_b32 s45, s45, 16
  s_max_u32 s45, s45, 20
  s_min_u32 s45, s45, 32
  s_mul_i32 s46, s42, s45
  s_add_u32 s47, s46, s45
  s_min_u32 s47, s47, s44
  s_cmp_ge_u32 s46, s44
  s_cbranch_scc1 A_FIN0
  v_add_u32 v61, s46, v61
  v_min_u32 v62, s47, v219
  v_cmp_gt_u32 vcc, v62, v61
  v_cmp_le_u32 s[94:95], v220, v61
  v_sub_u32 v221, v61, v60
  v_min_u32 v221, 255, v221
  v_lshl_add_u32 v62, v221, 2, v37
  ds_read_b32 v63, v62
  s_and_b64 s[94:95], s[94:95], vcc
  v_mov_b32 v64, 0x80000000
  s_and_b32 s54, s94, 0xffff
  s_or_b32 s54, s54, 0x8000
  s_ff1_i32_b32 s54, s54
  s_lshr_b32 s55, s94, 16
  s_or_b32 s55, s55, 0x8000
  s_ff1_i32_b32 s55, s55
  s_add_u32 s55, s55, 16
  s_and_b32 s56, s95, 0xffff
  s_or_b32 s56, s56, 0x8000
  s_ff1_i32_b32 s56, s56
  s_add_u32 s56, s56, 32
  s_lshr_b32 s57, s95, 16
  s_or_b32 s57, s57, 0x8000
  s_ff1_i32_b32 s57, s57
  s_add_u32 s57, s57, 48
  s_mov_b32 m0, s81
  s_waitcnt lgkmcnt(0)
  v_lshl_add_u32 v63, v63, 15, s82
  v_cndmask_b32 v63, v64, v63, s[94:95]
  s_nop 0
  v_readlane_b32 s60, v63, s54
  v_readlane_b32 s61, v63, s55
  v_readlane_b32 s62, v63, s56
  v_readlane_b32 s63, v63, s57
  s_nop 2
  s_cmp_eq_u32 s85, 1
  s_cselect_b32 s70, 4, 0
  s_cmp_lt_u32 s3, s70
  s_cbranch_scc0 A_KISS
  s_cmp_eq_u64 s[60:61], s[64:65]
  s_cbranch_scc0 A_KREDO
  s_cmp_eq_u64 s[62:63], s[66:67]
  s_cbranch_scc1 A_KDONE
A_KREDO:
  s_waitcnt vmcnt(0)
A_KISS:
  s_nop 0
  buffer_load_dwordx4 v16, s[24:27], s60 offen offset:0 nt lds
  buffer_load_dwordx4 v17, s[24:27], s60 offen offset:1024 nt lds
  buffer_load_dwordx4 v18, s[24:27], s60 offen offset:2048 nt lds
  buffer_load_dwordx4 v19, s[24:27], s60 offen offset:3072 nt lds
  s_add_u32 m0, s81, 4096
  s_nop 0
  buffer_load_dwordx4 v16, s[24:27], s61 offen offset:0 nt lds
  buffer_load_dwordx4 v17, s[24:27], s61 offen offset:1024 nt lds
  buffer_load_dwordx4 v18, s[24:27], s61 offen offset:2048 nt lds
  buffer_load_dwordx4 v19, s[24:27], s61 offen offset:3072 nt lds
  s_add_u32 m0, s81, 8192
  s_nop 0
  buffer_load_dwordx4 v16, s[24:27], s62 offen offset:0 nt lds
  buffer_load_dwordx4 v17, s[24:27], s62 offen offset:1024 nt lds
  buffer_load_dwordx4 v18, s[24:27], s62 offen offset:2048 nt lds
  buffer_load_dwordx4 v19, s[24:27], s62 offen offset:3072 nt lds
  s_add_u32 m0, s81, 12288
  s_nop 0
  buffer_load_dwordx4 v16, s[24:27], s63 offen offset:0 nt lds
  buffer_load_dwordx4 v17, s[24:27], s63 offen offset:1024 nt lds
  buffer_load_dwordx4 v18, s[24:27], s63 offen offset:2048 nt lds
  buffer_load_dwordx4 v19, s[24:27], s63 offen offset:3072 nt lds
A_KDONE:
  s_setprio 0
  v_lshlrev_b32 v52, 4, v221
  v_sub_u32 v52, v216, v52
  v_mov_b32 v53, 16
  v_cndmask_b32 v52, v52, v53, s[4:5]
  v_cndmask_b32 v52, 0, v52, s[94:95]
  s_and_b32 s90, s54, 15
  s_sub_u32 s90, s90, 1
  s_and_b32 s91, s55, 15
  s_sub_u32 s91, s91, 1
  s_and_b32 s92, s56, 15
  s_sub_u32 s92, s92, 1
  s_and_b32 s93, s57, 15
  s_sub_u32 s93, s93, 1
  v_readlane_b32 s64, v52, s54
  v_readlane_b32 s65, v52, s55
  v_readlane_b32 s66, v52, s56
  v_readlane_b32 s67, v52, s57
  v_cvt_f32_u32 v52, s45
  v_cmp_gt_u32 s[72:73], s47, v220
  v_rcp_f32 v52, v52
  v_cmp_lt_u32 s[74:75], s46, v219
  v_cmp_lt_u32 s[76:77], 0, v218
  v_cvt_f32_u32 v53, v220
  v_add_u32 v54, -1, v219
  v_cvt_f32_u32 v54, v54
  s_and_b32 s68, s72, s74
  s_and_b32 s68, s68, s76
  s_and_b32 s68, s68, 0x1ff
  v_mul_f32 v53, v53, v52
  v_mul_f32 v54, v54, v52
  v_add_f32 v53, 0x3ba3d70a, v53
  v_add_f32 v54, 0x3ba3d70a, v54
  v_cvt_u32_f32 v53, v53
  v_cvt_u32_f32 v54, v54
  s_bcnt1_i32_b32 s69, s68
  s_cmp_gt_u32 s69, 1
  s_cselect_b32 s51, 1, 0
  s_lshr_b32 s69, s68, 1
  v_readlane_b32 s49, v54, 0
  s_and_b32 s70, s69, 0xf
  s_cmp_eq_u32 s70, 0
  s_cselect_b32 s52, 1, 0
  s_lshr_b32 s71, s69, 4
  s_min_u32 s70, s70, 1
  s_min_u32 s71, s71, 1
  s_and_b32 s70, s70, s71
  s_and_b32 s71, s68, 1
  s_or_b32 s53, s70, s71
  s_cmp_lg_u32 s71, 0
  s_cselect_b32 s50, 0xff, s69
  s_add_u32 s49, s49, 1
  s_cmp_eq_u32 s41, 0
  s_cselect_b32 s49, 0, s49
  v_max_u32 v53, s49, v53
  v_add_u32 v54, 1, v54
  v_sub_u32 v54, v54, v53
  v_max_i32 v54, 0, v54
  v_cndmask_b32 v54, 0, v54, s[76:77]
  v_subrev_u32 v53, s49, v53
  v_add_u32 v54, s49, v54
  v_lshlrev_b32 v55, 2, v7
  v_add_u32 v55, 0x26800, v55
  ds_write_b32 v55, v53
  s_lshr_b32 s69, s101, 1
  s_and_b32 s69, s69, 7
  s_add_u32 s69, s69, 1
  v_readlane_b32 s86, v54, s69
  s_cmp_lg_u32 s53, 0
  s_cbranch_scc1 A_SHARED
  s_lshl_b32 s68, s52, 4
  s_add_u32 s68, s68, 0x26804
  v_lshl_add_u32 v60, v6, 2, s68
  v_lshl_add_u32 v62, v47, 2, s68
  ds_read_b32 v60, v60
  ds_read_b32 v62, v62
  s_lshl_b32 s68, s52, 12
  v_add_u32 v52, s68, v28
  v_add_u32 v53, s68, v29
  v_add_u32 v54, s68, v30
  v_add_u32 v55, s68, v31
  ds_read_b128 v[68:71], v52
  ds_read_b128 v[72:75], v53
  ds_read_b128 v[76:79], v54
  ds_read_b128 v[80:83], v55
  s_cmp_lt_u32 s42, s49
  s_cselect_b32 s69, 0, -1
  s_waitcnt lgkmcnt(0)
  v_and_b32 v60, s69, v60
  v_sub_u32 v60, s42, v60
  v_and_b32 v62, s69, v62
  v_sub_u32 v62, s42, v62
  v_lshl_add_u32 v60, v60, 11, v43
  v_lshl_add_u32 v62, v62, 4, v44
  s_lshl_b32 s68, s52, 2
  s_lshr_b32 s68, s50, s68
  v_lshrrev_b32 v5, v6, s68
  v_and_b32 v5, 1, v5
  v_cmp_ne_u32 s[8:9], 0, v5
  v_lshrrev_b32 v5, v47, s68
  v_and_b32 v5, 1, v5
  v_cmp_ne_u32 s[12:13], 0, v5
  s_and_b32 s12, s12, 0xffff
  s_mov_b32 s13, 0
  s_lshl_b32 s16, s43, 16
  s_lshl_b32 s70, s3, 8
  s_add_u32 s16, s16, s70
  s_lshl_b32 s70, s52, 21
  s_add_u32 s16, s16, s70
  s_add_u32 s17, s16, 32768
  s_add_u32 s22, s16, 2097152
  s_add_u32 s23, s17, 2097152
  s_waitcnt vmcnt(12)
  ds_read_b128 v[100:103], v24 offset:0
  ds_read_b128 v[104:107], v25 offset:0
  ds_read_b128 v[108:111], v26 offset:0
  ds_read_b128 v[112:115], v27 offset:0
  s_waitcnt lgkmcnt(0)
  v_mfma_f32_16x16x32_bf16 v[116:119], v[100:103], v[68:71], 0
  v_mfma_f32_16x16x32_bf16 v[116:119], v[104:107], v[72:75], v[116:119]
  v_mfma_f32_16x16x32_bf16 v[116:119], v[108:111], v[76:79], v[116:119]
  v_mfma_f32_16x16x32_bf16 v[116:119], v[112:115], v[80:83], v[116:119]
  s_waitcnt vmcnt(8)
  ds_read_b128 v[100:103], v24 offset:4096
  ds_read_b128 v[104:107], v25 offset:4096
  ds_read_b128 v[108:111], v26 offset:4096
  ds_read_b128 v[112:115], v27 offset:4096
  s_waitcnt lgkmcnt(0)
  v_mfma_f32_16x16x32_bf16 v[120:123], v[100:103], v[68:71], 0
  v_mfma_f32_16x16x32_bf16 v[120:123], v[104:107], v[72:75], v[120:123]
  v_mfma_f32_16x16x32_bf16 v[120:123], v[108:111], v[76:79], v[120:123]
  v_mfma_f32_16x16x32_bf16 v[120:123], v[112:115], v[80:83], v[120:123]
  s_waitcnt vmcnt(4)
  ds_read_b128 v[100:103], v24 offset:8192
  ds_read_b128 v[104:107], v25 offset:8192
  ds_read_b128 v[108:111], v26 offset:8192
  ds_read_b128 v[112:115], v27 offset:8192
  s_waitcnt lgkmcnt(0)
  v_mfma_f32_16x16x32_bf16 v[124:127], v[100:103], v[68:71], 0
  v_mfma_f32_16x16x32_bf16 v[124:127], v[104:107], v[72:75], v[124:127]
  v_mfma_f32_16x16x32_bf16 v[124:127], v[108:111], v[76:79], v[124:127]
  v_mfma_f32_16x16x32_bf16 v[124:127], v[112:115], v[80:83], v[124:127]
  s_waitcnt vmcnt(0)
  ds_read_b128 v[100:103], v24 offset:12288
  ds_read_b128 v[104:107], v25 offset:12288
  ds_read_b128 v[108:111], v26 offset:12288
  ds_read_b128 v[112:115], v27 offset:12288
  s_waitcnt lgkmcnt(0)
  v_mfma_f32_16x16x32_bf16 v[128:131], v[100:103], v[68:71], 0
  v_mfma_f32_16x16x32_bf16 v[128:131], v[104:107], v[72:75], v[128:131]
  v_mfma_f32_16x16x32_bf16 v[128:131], v[108:111], v[76:79], v[128:131]
  v_mfma_f32_16x16x32_bf16 v[128:131], v[112:115], v[80:83], v[128:131]
  s_nop 7
  s_cmp_lt_i32 s64, 16
  s_cbranch_scc1 B1_DM0
  s_cmp_eq_u32 s51, 0
  s_cbranch_scc1 B1_NM0
  s_cmp_eq_u32 s90, -1
  s_cbranch_scc1 B1_NM0
B1_DM0:
  v_cmp_gt_i32 s[72:73], s64, v38
  v_cmp_gt_i32 s[74:75], s64, v39
  v_cmp_gt_i32 s[76:77], s64, v40
  v_cmp_gt_i32 s[78:79], s64, v41
  s_lshl_b32 s68, s52, 2
  s_sub_u32 s68, s90, s68
  v_cmp_eq_u32 s[96:97], s68, v47
  s_cmp_eq_u32 s90, -1
  s_cselect_b64 s[96:97], -1, s[96:97]
  s_and_b64 vcc, s[72:73], s[96:97]
  v_cndmask_b32 v116, v46, v116, vcc
  s_and_b64 vcc, s[74:75], s[96:97]
  v_cndmask_b32 v117, v46, v117, vcc
  s_and_b64 vcc, s[76:77], s[96:97]
  v_cndmask_b32 v118, v46, v118, vcc
  s_and_b64 vcc, s[78:79], s[96:97]
  v_cndmask_b32 v119, v46, v119, vcc
B1_NM0:
  s_cmp_lt_i32 s65, 16
  s_cbranch_scc1 B1_DM1
  s_cmp_eq_u32 s51, 0
  s_cbranch_scc1 B1_NM1
  s_cmp_eq_u32 s91, -1
  s_cbranch_scc1 B1_NM1
B1_DM1:
  v_cmp_gt_i32 s[72:73], s65, v38
  v_cmp_gt_i32 s[74:75], s65, v39
  v_cmp_gt_i32 s[76:77], s65, v40
  v_cmp_gt_i32 s[78:79], s65, v41
  s_lshl_b32 s68, s52, 2
  s_sub_u32 s68, s91, s68
  v_cmp_eq_u32 s[96:97], s68, v47
  s_cmp_eq_u32 s91, -1
  s_cselect_b64 s[96:97], -1, s[96:97]
  s_and_b64 vcc, s[72:73], s[96:97]
  v_cndmask_b32 v120, v46, v120, vcc
  s_and_b64 vcc, s[74:75], s[96:97]
  v_cndmask_b32 v121, v46, v121, vcc
  s_and_b64 vcc, s[76:77], s[96:97]
  v_cndmask_b32 v122, v46, v122, vcc
  s_and_b64 vcc, s[78:79], s[96:97]
  v_cndmask_b32 v123, v46, v123, vcc
B1_NM1:
  s_cmp_lt_i32 s66, 16
  s_cbranch_scc1 B1_DM2
  s_cmp_eq_u32 s51, 0
  s_cbranch_scc1 B1_NM2
  s_cmp_eq_u32 s92, -1
  s_cbranch_scc1 B1_NM2
B1_DM2:
  v_cmp_gt_i32 s[72:73], s66, v38
  v_cmp_gt_i32 s[74:75], s66, v39
  v_cmp_gt_i32 s[76:77], s66, v40
  v_cmp_gt_i32 s[78:79], s66, v41
  s_lshl_b32 s68, s52, 2
  s_sub_u32 s68, s92, s68
  v_cmp_eq_u32 s[96:97], s68, v47
  s_cmp_eq_u32 s92, -1
  s_cselect_b64 s[96:97], -1, s[96:97]
  s_and_b64 vcc, s[72:73], s[96:97]
  v_cndmask_b32 v124, v46, v124, vcc
  s_and_b64 vcc, s[74:75], s[96:97]
  v_cndmask_b32 v125, v46, v125, vcc
  s_and_b64 vcc, s[76:77], s[96:97]
  v_cndmask_b32 v126, v46, v126, vcc
  s_and_b64 vcc, s[78:79], s[96:97]
  v_cndmask_b32 v127, v46, v127, vcc
B1_NM2:
  s_cmp_lt_i32 s67, 16
  s_cbranch_scc1 B1_DM3
  s_cmp_eq_u32 s51, 0
  s_cbranch_scc1 B1_NM3
  s_cmp_eq_u32 s93, -1
  s_cbranch_scc1 B1_NM3
B1_DM3:
  v_cmp_gt_i32 s[72:73], s67, v38
  v_cmp_gt_i32 s[74:75], s67, v39
  v_cmp_gt_i32 s[76:77], s67, v40
  v_cmp_gt_i32 s[78:79], s67, v41
  s_lshl_b32 s68, s52, 2
  s_sub_u32 s68, s93, s68
  v_cmp_eq_u32 s[96:97], s68, v47
  s_cmp_eq_u32 s93, -1
  s_cselect_b64 s[96:97], -1, s[96:97]
  s_and_b64 vcc, s[72:73], s[96:97]
  v_cndmask_b32 v128, v46, v128, vcc
  s_and_b64 vcc, s[74:75], s[96:97]
  v_cndmask_b32 v129, v46, v129, vcc
  s_and_b64 vcc, s[76:77], s[96:97]
  v_cndmask_b32 v130, v46, v130, vcc
  s_and_b64 vcc, s[78:79], s[96:97]
  v_cndmask_b32 v131, v46, v131, vcc
B1_NM3:
  v_max3_f32 v53, v116, v117, v118
  v_max3_f32 v53, v53, v119, v120
  v_max3_f32 v53, v53, v121, v122
  v_max3_f32 v53, v53, v123, v124
  v_max3_f32 v53, v53, v125, v126
  v_max3_f32 v53, v53, v127, v128
  v_max3_f32 v53, v53, v129, v130
  v_max_f32 v53, v53, v131
  v_mov_b32 v54, v53
  s_nop 1
  v_permlane16_swap_b32 v53, v54
  s_nop 0
  v_max_f32 v53, v53, v54
  v_mov_b32 v54, v53
  s_nop 1
  v_permlane32_swap_b32 v53, v54
  s_nop 0
  v_max_f32 v53, v53, v54
  s_lshl_b32 s68, s3, 2
  v_add_u32 v2, s68, v36
  ds_write_b32 v2, v53 offset:0
  s_lshl_b32 s68, s3, 2
  v_add_u32 v5, s68, v199
  v_mov_b32 v4, s85
  ds_write_b32 v5, v4 offset:0
  s_add_u32 m0, s81, 0
  s_nop 0
  buffer_load_dwordx4 v20, s[28:31], s60 offen offset:0 nt lds
  buffer_load_dwordx4 v21, s[28:31], s60 offen offset:1024 nt lds
  buffer_load_dwordx4 v22, s[28:31], s60 offen offset:2048 nt lds
  buffer_load_dwordx4 v23, s[28:31], s60 offen offset:3072 nt lds
  s_cmp_ge_u32 s3, 4
  s_cbranch_scc1 B1_V1
  s_add_u32 m0, s81, 4096
  s_nop 0
  buffer_load_dwordx4 v20, s[28:31], s61 offen offset:0 nt lds
  buffer_load_dwordx4 v21, s[28:31], s61 offen offset:1024 nt lds
  buffer_load_dwordx4 v22, s[28:31], s61 offen offset:2048 nt lds
  buffer_load_dwordx4 v23, s[28:31], s61 offen offset:3072 nt lds
  s_add_u32 m0, s81, 8192
  s_nop 0
  buffer_load_dwordx4 v20, s[28:31], s62 offen offset:0 nt lds
  buffer_load_dwordx4 v21, s[28:31], s62 offen offset:1024 nt lds
  buffer_load_dwordx4 v22, s[28:31], s62 offen offset:2048 nt lds
  buffer_load_dwordx4 v23, s[28:31], s62 offen offset:3072 nt lds
  s_add_u32 m0, s81, 12288
  s_nop 0
  buffer_load_dwordx4 v20, s[28:31], s63 offen offset:0 nt lds
  buffer_load_dwordx4 v21, s[28:31], s63 offen offset:1024 nt lds
  buffer_load_dwordx4 v22, s[28:31], s63 offen offset:2048 nt lds
  buffer_load_dwordx4 v23, s[28:31], s63 offen offset:3072 nt lds
B1_V1:
  s_load_dword s58, s[20:21], 0
B1_PM:
  ds_read_b128 v[52:55], v199 offset:0
  ds_read_b128 v[56:59], v199 offset:16
  s_waitcnt lgkmcnt(0)
  v_min3_u32 v52, v52, v53, v54
  v_min3_u32 v55, v55, v56, v57
  v_min3_u32 v52, v52, v58, v59
  v_min_u32 v52, v52, v55
  v_cmp_gt_u32 vcc, s85, v52
  s_cbranch_vccnz B1_PM
  ds_read_b128 v[100:103], v36 offset:0
  ds_read_b128 v[104:107], v36 offset:16
  s_waitcnt lgkmcnt(0)
  v_max3_f32 v100, v100, v101, v102
  v_max3_f32 v103, v103, v104, v105
  v_max3_f32 v100, v100, v106, v107
  v_max_f32 v100, v100, v103
  v_mul_f32 v48, s80, v100
  v_fma_f32 v116, v116, s80, -v48
  v_fma_f32 v117, v117, s80, -v48
  v_fma_f32 v118, v118, s80, -v48
  v_fma_f32 v119, v119, s80, -v48
  v_fma_f32 v120, v120, s80, -v48
  v_fma_f32 v121, v121, s80, -v48
  v_fma_f32 v122, v122, s80, -v48
  v_fma_f32 v123, v123, s80, -v48
  v_fma_f32 v124, v124, s80, -v48
  v_fma_f32 v125, v125, s80, -v48
  v_fma_f32 v126, v126, s80, -v48
  v_fma_f32 v127, v127, s80, -v48
  v_fma_f32 v128, v128, s80, -v48
  v_fma_f32 v129, v129, s80, -v48
  v_fma_f32 v130, v130, s80, -v48
  v_fma_f32 v131, v131, s80, -v48
  v_exp_f32 v116, v116
  v_exp_f32 v117, v117
  v_exp_f32 v118, v118
  v_exp_f32 v119, v119
  v_exp_f32 v120, v120
  v_exp_f32 v121, v121
  v_exp_f32 v122, v122
  v_exp_f32 v123, v123
  v_exp_f32 v124, v124
  v_exp_f32 v125, v125
  v_exp_f32 v126, v126
  v_exp_f32 v127, v127
  v_exp_f32 v128, v128
  v_exp_f32 v129, v129
  v_exp_f32 v130, v130
  v_exp_f32 v131, v131
  s_nop 0
  v_cvt_pk_bf16_f32 v148, v116, v117
  v_cvt_pk_bf16_f32 v149, v118, v119
  v_cvt_pk_bf16_f32 v150, v120, v121
  v_cvt_pk_bf16_f32 v151, v122, v123
  v_cvt_pk_bf16_f32 v152, v124, v125
  v_cvt_pk_bf16_f32 v153, v126, v127
  v_cvt_pk_bf16_f32 v154, v128, v129
  v_cvt_pk_bf16_f32 v155, v130, v131
  ds_write_b64 v35, v[148:149] offset:0
  ds_write_b64 v35, v[150:151] offset:4096
  ds_write_b64 v35, v[152:153] offset:8192
  ds_write_b64 v35, v[154:155] offset:12288
  v_add_f32 v116, v116, v117
  v_add_f32 v118, v118, v119
  v_add_f32 v120, v120, v121
  v_add_f32 v122, v122, v123
  v_add_f32 v124, v124, v125
  v_add_f32 v126, v126, v127
  v_add_f32 v128, v128, v129
  v_add_f32 v130, v130, v131
  v_add_f32 v116, v116, v118
  v_add_f32 v120, v120, v122
  v_add_f32 v124, v124, v126
  v_add_f32 v128, v128, v130
  v_add_f32 v116, v116, v120
  v_add_f32 v124, v124, v128
  v_add_f32 v53, v116, v124
  v_mov_b32 v54, v53
  s_nop 1
  v_permlane16_swap_b32 v53, v54
  s_nop 0
  v_add_f32 v53, v53, v54
  v_mov_b32 v54, v53
  s_nop 1
  v_permlane32_swap_b32 v53, v54
  s_nop 0
  v_add_f32 v53, v53, v54
  v_add_u32 v2, 1024, v2
  ds_write_b32 v2, v53 offset:0
  s_lshl_b32 s68, s3, 2
  v_add_u32 v5, s68, v199
  v_mov_b32 v4, s85
  ds_write_b32 v5, v4 offset:32
  s_cmp_lt_u32 s3, 4
  s_cbranch_scc1 B1_V2
  s_add_u32 m0, s81, 4096
  s_nop 0
  buffer_load_dwordx4 v20, s[28:31], s61 offen offset:0 nt lds
  buffer_load_dwordx4 v21, s[28:31], s61 offen offset:1024 nt lds
  buffer_load_dwordx4 v22, s[28:31], s61 offen offset:2048 nt lds
  buffer_load_dwordx4 v23, s[28:31], s61 offen offset:3072 nt lds
  s_add_u32 m0, s81, 8192
  s_nop 0
  buffer_load_dwordx4 v20, s[28:31], s62 offen offset:0 nt lds
  buffer_load_dwordx4 v21, s[28:31], s62 offen offset:1024 nt lds
  buffer_load_dwordx4 v22, s[28:31], s62 offen offset:2048 nt lds
  buffer_load_dwordx4 v23, s[28:31], s62 offen offset:3072 nt lds
  s_add_u32 m0, s81, 12288
  s_nop 0
  buffer_load_dwordx4 v20, s[28:31], s63 offen offset:0 nt lds
  buffer_load_dwordx4 v21, s[28:31], s63 offen offset:1024 nt lds
  buffer_load_dwordx4 v22, s[28:31], s63 offen offset:2048 nt lds
  buffer_load_dwordx4 v23, s[28:31], s63 offen offset:3072 nt lds
B1_V2:
B1_PP:
  ds_read_b128 v[52:55], v199 offset:32
  ds_read_b128 v[56:59], v199 offset:48
  s_waitcnt lgkmcnt(0)
  v_min3_u32 v52, v52, v53, v54
  v_min3_u32 v55, v55, v56, v57
  v_min3_u32 v52, v52, v58, v59
  v_min_u32 v52, v52, v55
  v_cmp_gt_u32 vcc, s85, v52
  s_cbranch_vccnz B1_PP
  ds_read_b128 v[68:71], v34 offset:0
  ds_read_b128 v[72:75], v34 offset:1024
  ds_read_b128 v[76:79], v34 offset:2048
  ds_read_b128 v[80:83], v34 offset:3072
  ds_read_b128 v[84:87], v34 offset:4096
  ds_read_b128 v[88:91], v34 offset:5120
  ds_read_b128 v[92:95], v34 offset:6144
  ds_read_b128 v[96:99], v34 offset:7168
  ds_read_b128 v[100:103], v34 offset:8192
  ds_read_b128 v[104:107], v34 offset:9216
  ds_read_b128 v[108:111], v34 offset:10240
  ds_read_b128 v[112:115], v34 offset:11264
  s_waitcnt lgkmcnt(4)
  ds_read_b128 v[116:119], v34 offset:12288
  ds_read_b128 v[120:123], v34 offset:13312
  ds_read_b128 v[124:127], v34 offset:14336
  ds_read_b128 v[128:131], v34 offset:15360
  v_mov_b32 v197, s58
  v_cmp_eq_u32 vcc, 0, v197
  s_cbranch_vccz B1_NOK
  s_mov_b32 s88, 0
B1_NSPIN:
  global_load_dword v197, v198, s[20:21] sc1
  s_waitcnt vmcnt(0)
  s_add_u32 s88, s88, 1
  s_cmp_ge_u32 s88, 0x40000
  s_cbranch_scc1 B1_NOK
  v_cmp_eq_u32 vcc, 0, v197
  s_cbranch_vccnz B1_NSPIN
B1_NOK:
  v_mov_b32 v201, v197
  v_mov_b32 v203, v197
  v_mov_b32 v205, v197
  v_mov_b32 v207, v197
  s_waitcnt lgkmcnt(0)
  s_cmp_lg_u32 s3, 0
  s_cbranch_scc1 B1_NOMLP
  ds_read_b128 v[164:167], v36 offset:1024
  ds_read_b128 v[168:171], v36 offset:1040
  s_waitcnt lgkmcnt(0)
  v_add_f32 v164, v164, v168
  v_add_f32 v165, v165, v169
  v_add_f32 v166, v166, v170
  v_add_f32 v167, v167, v171
  v_add_f32 v164, v164, v165
  v_add_f32 v166, v166, v167
  v_add_f32 v58, v164, v166
  v_mov_b32 v56, v48
  v_mov_b32 v57, v197
  v_mov_b32 v59, v197
B1_NOMLP:
  s_cmp_lg_u32 s3, 0
  s_cbranch_scc1 B1_NOML
  s_lshl_b32 s69, s43, 10
  s_add_u32 s69, s69, 0x400000
  s_lshl_b32 s70, s52, 15
  s_add_u32 s69, s69, s70
  s_mov_b64 exec, s[12:13]
  buffer_store_dwordx4 v[56:59], v62, s[36:39], s69 offen sc1
  s_mov_b64 exec, -1
B1_NOML:
  s_waitcnt vmcnt(12) lgkmcnt(0)
  s_barrier
  ds_read_b64_tr_b16 v[164:165], v32 offset:0
  ds_read_b64_tr_b16 v[166:167], v32 offset:16384
  ds_read_b64_tr_b16 v[168:169], v32 offset:32768
  ds_read_b64_tr_b16 v[170:171], v32 offset:49152
  ds_read_b64_tr_b16 v[172:173], v33 offset:0
  ds_read_b64_tr_b16 v[174:175], v33 offset:16384
  ds_read_b64_tr_b16 v[176:177], v33 offset:32768
  ds_read_b64_tr_b16 v[178:179], v33 offset:49152
  s_waitcnt lgkmcnt(6)
  v_mfma_f32_16x16x32_bf16 v[188:191], v[68:71], v[164:167], 0
  s_waitcnt lgkmcnt(4)
  v_mfma_f32_16x16x32_bf16 v[188:191], v[72:75], v[168:171], v[188:191]
  s_waitcnt lgkmcnt(2)
  v_mfma_f32_16x16x32_bf16 v[188:191], v[76:79], v[172:175], v[188:191]
  s_waitcnt lgkmcnt(0)
  v_mfma_f32_16x16x32_bf16 v[188:191], v[80:83], v[176:179], v[188:191]
  s_waitcnt vmcnt(8) lgkmcnt(0)
  s_barrier
  ds_read_b64_tr_b16 v[164:165], v32 offset:4096
  ds_read_b64_tr_b16 v[166:167], v32 offset:20480
  ds_read_b64_tr_b16 v[168:169], v32 offset:36864
  ds_read_b64_tr_b16 v[170:171], v32 offset:53248
  ds_read_b64_tr_b16 v[172:173], v33 offset:4096
  ds_read_b64_tr_b16 v[174:175], v33 offset:20480
  ds_read_b64_tr_b16 v[176:177], v33 offset:36864
  ds_read_b64_tr_b16 v[178:179], v33 offset:53248
  s_waitcnt lgkmcnt(6)
  v_mfma_f32_16x16x32_bf16 v[188:191], v[84:87], v[164:167], v[188:191]
  s_waitcnt lgkmcnt(4)
  v_mfma_f32_16x16x32_bf16 v[188:191], v[88:91], v[168:171], v[188:191]
  s_waitcnt lgkmcnt(2)
  v_mfma_f32_16x16x32_bf16 v[188:191], v[92:95], v[172:175], v[188:191]
  s_waitcnt lgkmcnt(0)
  v_mfma_f32_16x16x32_bf16 v[188:191], v[96:99], v[176:179], v[188:191]
  s_waitcnt vmcnt(4) lgkmcnt(0)
  s_barrier
  ds_read_b64_tr_b16 v[164:165], v32 offset:8192
  ds_read_b64_tr_b16 v[166:167], v32 offset:24576
  ds_read_b64_tr_b16 v[168:169], v32 offset:40960
  ds_read_b64_tr_b16 v[170:171], v32 offset:57344
  ds_read_b64_tr_b16 v[172:173], v33 offset:8192
  ds_read_b64_tr_b16 v[174:175], v33 offset:24576
  ds_read_b64_tr_b16 v[176:177], v33 offset:40960
  ds_read_b64_tr_b16 v[178:179], v33 offset:57344
  s_waitcnt lgkmcnt(6)
  v_mfma_f32_16x16x32_bf16 v[188:191], v[100:103], v[164:167], v[188:191]
  s_waitcnt lgkmcnt(4)
  v_mfma_f32_16x16x32_bf16 v[188:191], v[104:107], v[168:171], v[188:191]
  s_waitcnt lgkmcnt(2)
  v_mfma_f32_16x16x32_bf16 v[188:191], v[108:111], v[172:175], v[188:191]
  s_waitcnt lgkmcnt(0)
  v_mfma_f32_16x16x32_bf16 v[188:191], v[112:115], v[176:179], v[188:191]
  s_waitcnt vmcnt(0) lgkmcnt(0)
  s_barrier
  ds_read_b64_tr_b16 v[164:165], v32 offset:12288
  ds_read_b64_tr_b16 v[166:167], v32 offset:28672
  ds_read_b64_tr_b16 v[168:169], v32 offset:45056
  ds_read_b64_tr_b16 v[170:171], v32 offset:61440
  ds_read_b64_tr_b16 v[172:173], v33 offset:12288
  ds_read_b64_tr_b16 v[174:175], v33 offset:28672
  ds_read_b64_tr_b16 v[176:177], v33 offset:45056
  ds_read_b64_tr_b16 v[178:179], v33 offset:61440
  s_waitcnt lgkmcnt(6)
  v_mfma_f32_16x16x32_bf16 v[188:191], v[116:119], v[164:167], v[188:191]
  s_waitcnt lgkmcnt(4)
  v_mfma_f32_16x16x32_bf16 v[188:191], v[120:123], v[168:171], v[188:191]
  s_waitcnt lgkmcnt(2)
  v_mfma_f32_16x16x32_bf16 v[188:191], v[124:127], v[172:175], v[188:191]
  s_waitcnt lgkmcnt(0)
  v_mfma_f32_16x16x32_bf16 v[188:191], v[128:131], v[176:179], v[188:191]
  s_nop 7
  v_bfi_b32 v200, s87, v197, v188
  v_bfi_b32 v202, s87, v197, v189
  v_bfi_b32 v204, s87, v197, v190
  v_bfi_b32 v206, s87, v197, v191
  s_mov_b64 exec, s[8:9]
  buffer_store_dwordx4 v[200:203], v60, s[36:39], s16 offen sc1
  buffer_store_dwordx4 v[204:207], v60, s[36:39], s17 offen sc1
  s_mov_b64 exec, -1
  s_branch A_NEXT
A_SHARED:
  s_mov_b32 s68, 0x26804
  v_lshl_add_u32 v60, v6, 2, s68
  v_lshl_add_u32 v62, v47, 2, s68
  ds_read_b32 v60, v60
  ds_read_b32 v62, v62
  s_mov_b32 s68, 0x26814
  v_lshl_add_u32 v61, v6, 2, s68
  v_lshl_add_u32 v63, v47, 2, s68
  ds_read_b32 v61, v61
  ds_read_b32 v63, v63
  ds_read_b128 v[68:71], v28 offset:0
  ds_read_b128 v[72:75], v29 offset:0
  ds_read_b128 v[76:79], v30 offset:0
  ds_read_b128 v[80:83], v31 offset:0
  ds_read_b128 v[84:87], v28 offset:4096
  ds_read_b128 v[88:91], v29 offset:4096
  ds_read_b128 v[92:95], v30 offset:4096
  ds_read_b128 v[96:99], v31 offset:4096
  s_cmp_lt_u32 s42, s49
  s_cselect_b32 s69, 0, -1
  s_waitcnt lgkmcnt(0)
  v_and_b32 v60, s69, v60
  v_sub_u32 v60, s42, v60
  v_and_b32 v62, s69, v62
  v_sub_u32 v62, s42, v62
  v_lshl_add_u32 v60, v60, 11, v43
  v_lshl_add_u32 v62, v62, 4, v44
  s_lshr_b32 s68, s50, 0
  v_lshrrev_b32 v5, v6, s68
  v_and_b32 v5, 1, v5
  v_cmp_ne_u32 s[8:9], 0, v5
  v_lshrrev_b32 v5, v47, s68
  v_and_b32 v5, 1, v5
  v_cmp_ne_u32 s[12:13], 0, v5
  s_and_b32 s12, s12, 0xffff
  s_mov_b32 s13, 0
  v_and_b32 v61, s69, v61
  v_sub_u32 v61, s42, v61
  v_and_b32 v63, s69, v63
  v_sub_u32 v63, s42, v63
  v_lshl_add_u32 v61, v61, 11, v43
  v_lshl_add_u32 v63, v63, 4, v44
  s_lshr_b32 s68, s50, 4
  v_lshrrev_b32 v5, v6, s68
  v_and_b32 v5, 1, v5
  v_cmp_ne_u32 s[10:11], 0, v5
  v_lshrrev_b32 v5, v47, s68
  v_and_b32 v5, 1, v5
  v_cmp_ne_u32 s[14:15], 0, v5
  s_and_b32 s14, s14, 0xffff
  s_mov_b32 s15, 0
  s_lshl_b32 s16, s43, 16
  s_lshl_b32 s70, s3, 8
  s_add_u32 s16, s16, s70
  s_add_u32 s17, s16, 32768
  s_add_u32 s22, s16, 2097152
  s_add_u32 s23, s17, 2097152
  s_waitcnt vmcnt(12)
  ds_read_b128 v[100:103], v24 offset:0
  ds_read_b128 v[104:107], v25 offset:0
  ds_read_b128 v[108:111], v26 offset:0
  ds_read_b128 v[112:115], v27 offset:0
  s_waitcnt lgkmcnt(0)
  v_mfma_f32_16x16x32_bf16 v[116:119], v[100:103], v[68:71], 0
  v_mfma_f32_16x16x32_bf16 v[116:119], v[104:107], v[72:75], v[116:119]
  v_mfma_f32_16x16x32_bf16 v[116:119], v[108:111], v[76:79], v[116:119]
  v_mfma_f32_16x16x32_bf16 v[116:119], v[112:115], v[80:83], v[116:119]
  v_mfma_f32_16x16x32_bf16 v[132:135], v[100:103], v[84:87], 0
  v_mfma_f32_16x16x32_bf16 v[132:135], v[104:107], v[88:91], v[132:135]
  v_mfma_f32_16x16x32_bf16 v[132:135], v[108:111], v[92:95], v[132:135]
  v_mfma_f32_16x16x32_bf16 v[132:135], v[112:115], v[96:99], v[132:135]
  s_waitcnt vmcnt(8)
  ds_read_b128 v[100:103], v24 offset:4096
  ds_read_b128 v[104:107], v25 offset:4096
  ds_read_b128 v[108:111], v26 offset:4096
  ds_read_b128 v[112:115], v27 offset:4096
  s_waitcnt lgkmcnt(0)
  v_mfma_f32_16x16x32_bf16 v[120:123], v[100:103], v[68:71], 0
  v_mfma_f32_16x16x32_bf16 v[120:123], v[104:107], v[72:75], v[120:123]
  v_mfma_f32_16x16x32_bf16 v[120:123], v[108:111], v[76:79], v[120:123]
  v_mfma_f32_16x16x32_bf16 v[120:123], v[112:115], v[80:83], v[120:123]
  v_mfma_f32_16x16x32_bf16 v[136:139], v[100:103], v[84:87], 0
  v_mfma_f32_16x16x32_bf16 v[136:139], v[104:107], v[88:91], v[136:139]
  v_mfma_f32_16x16x32_bf16 v[136:139], v[108:111], v[92:95], v[136:139]
  v_mfma_f32_16x16x32_bf16 v[136:139], v[112:115], v[96:99], v[136:139]
  s_waitcnt vmcnt(4)
  ds_read_b128 v[100:103], v24 offset:8192
  ds_read_b128 v[104:107], v25 offset:8192
  ds_read_b128 v[108:111], v26 offset:8192
  ds_read_b128 v[112:115], v27 offset:8192
  s_waitcnt lgkmcnt(0)
  v_mfma_f32_16x16x32_bf16 v[124:127], v[100:103], v[68:71], 0
  v_mfma_f32_16x16x32_bf16 v[124:127], v[104:107], v[72:75], v[124:127]
  v_mfma_f32_16x16x32_bf16 v[124:127], v[108:111], v[76:79], v[124:127]
  v_mfma_f32_16x16x32_bf16 v[124:127], v[112:115], v[80:83], v[124:127]
  v_mfma_f32_16x16x32_bf16 v[140:143], v[100:103], v[84:87], 0
  v_mfma_f32_16x16x32_bf16 v[140:143], v[104:107], v[88:91], v[140:143]
  v_mfma_f32_16x16x32_bf16 v[140:143], v[108:111], v[92:95], v[140:143]
  v_mfma_f32_16x16x32_bf16 v[140:143], v[112:115], v[96:99], v[140:143]
  s_waitcnt vmcnt(0)
  ds_read_b128 v[100:103], v24 offset:12288
  ds_read_b128 v[104:107], v25 offset:12288
  ds_read_b128 v[108:111], v26 offset:12288
  ds_read_b128 v[112:115], v27 offset:12288
  s_waitcnt lgkmcnt(0)
  v_mfma_f32_16x16x32_bf16 v[128:131], v[100:103], v[68:71], 0
  v_mfma_f32_16x16x32_bf16 v[128:131], v[104:107], v[72:75], v[128:131]
  v_mfma_f32_16x16x32_bf16 v[128:131], v[108:111], v[76:79], v[128:131]
  v_mfma_f32_16x16x32_bf16 v[128:131], v[112:115], v[80:83], v[128:131]
  v_mfma_f32_16x16x32_bf16 v[144:147], v[100:103], v[84:87], 0
  v_mfma_f32_16x16x32_bf16 v[144:147], v[104:107], v[88:91], v[144:147]
  v_mfma_f32_16x16x32_bf16 v[144:147], v[108:111], v[92:95], v[144:147]
  v_mfma_f32_16x16x32_bf16 v[144:147], v[112:115], v[96:99], v[144:147]
  s_nop 7
  s_cmp_lt_i32 s64, 16
  s_cbranch_scc1 B2_DM0
  s_cmp_eq_u32 s51, 0
  s_cbranch_scc1 B2_NM0
  s_cmp_eq_u32 s90, -1
  s_cbranch_scc1 B2_NM0
B2_DM0:
  v_cmp_gt_i32 s[72:73], s64, v38
  v_cmp_gt_i32 s[74:75], s64, v39
  v_cmp_gt_i32 s[76:77], s64, v40
  v_cmp_gt_i32 s[78:79], s64, v41
  s_sub_u32 s68, s90, 0
  v_cmp_eq_u32 s[96:97], s68, v47
  s_cmp_eq_u32 s90, -1
  s_cselect_b64 s[96:97], -1, s[96:97]
  s_sub_u32 s68, s90, 4
  v_cmp_eq_u32 s[98:99], s68, v47
  s_cmp_eq_u32 s90, -1
  s_cselect_b64 s[98:99], -1, s[98:99]
  s_and_b64 vcc, s[72:73], s[96:97]
  v_cndmask_b32 v116, v46, v116, vcc
  s_and_b64 vcc, s[74:75], s[96:97]
  v_cndmask_b32 v117, v46, v117, vcc
  s_and_b64 vcc, s[76:77], s[96:97]
  v_cndmask_b32 v118, v46, v118, vcc
  s_and_b64 vcc, s[78:79], s[96:97]
  v_cndmask_b32 v119, v46, v119, vcc
  s_and_b64 vcc, s[72:73], s[98:99]
  v_cndmask_b32 v132, v46, v132, vcc
  s_and_b64 vcc, s[74:75], s[98:99]
  v_cndmask_b32 v133, v46, v133, vcc
  s_and_b64 vcc, s[76:77], s[98:99]
  v_cndmask_b32 v134, v46, v134, vcc
  s_and_b64 vcc, s[78:79], s[98:99]
  v_cndmask_b32 v135, v46, v135, vcc
B2_NM0:
  s_cmp_lt_i32 s65, 16
  s_cbranch_scc1 B2_DM1
  s_cmp_eq_u32 s51, 0
  s_cbranch_scc1 B2_NM1
  s_cmp_eq_u32 s91, -1
  s_cbranch_scc1 B2_NM1
B2_DM1:
  v_cmp_gt_i32 s[72:73], s65, v38
  v_cmp_gt_i32 s[74:75], s65, v39
  v_cmp_gt_i32 s[76:77], s65, v40
  v_cmp_gt_i32 s[78:79], s65, v41
  s_sub_u32 s68, s91, 0
  v_cmp_eq_u32 s[96:97], s68, v47
  s_cmp_eq_u32 s91, -1
  s_cselect_b64 s[96:97], -1, s[96:97]
  s_sub_u32 s68, s91, 4
  v_cmp_eq_u32 s[98:99], s68, v47
  s_cmp_eq_u32 s91, -1
  s_cselect_b64 s[98:99], -1, s[98:99]
  s_and_b64 vcc, s[72:73], s[96:97]
  v_cndmask_b32 v120, v46, v120, vcc
  s_and_b64 vcc, s[74:75], s[96:97]
  v_cndmask_b32 v121, v46, v121, vcc
  s_and_b64 vcc, s[76:77], s[96:97]
  v_cndmask_b32 v122, v46, v122, vcc
  s_and_b64 vcc, s[78:79], s[96:97]
  v_cndmask_b32 v123, v46, v123, vcc
  s_and_b64 vcc, s[72:73], s[98:99]
  v_cndmask_b32 v136, v46, v136, vcc
  s_and_b64 vcc, s[74:75], s[98:99]
  v_cndmask_b32 v137, v46, v137, vcc
  s_and_b64 vcc, s[76:77], s[98:99]
  v_cndmask_b32 v138, v46, v138, vcc
  s_and_b64 vcc, s[78:79], s[98:99]
  v_cndmask_b32 v139, v46, v139, vcc
B2_NM1:
  s_cmp_lt_i32 s66, 16
  s_cbranch_scc1 B2_DM2
  s_cmp_eq_u32 s51, 0
  s_cbranch_scc1 B2_NM2
  s_cmp_eq_u32 s92, -1
  s_cbranch_scc1 B2_NM2
B2_DM2:
  v_cmp_gt_i32 s[72:73], s66, v38
  v_cmp_gt_i32 s[74:75], s66, v39
  v_cmp_gt_i32 s[76:77], s66, v40
  v_cmp_gt_i32 s[78:79], s66, v41
  s_sub_u32 s68, s92, 0
  v_cmp_eq_u32 s[96:97], s68, v47
  s_cmp_eq_u32 s92, -1
  s_cselect_b64 s[96:97], -1, s[96:97]
  s_sub_u32 s68, s92, 4
  v_cmp_eq_u32 s[98:99], s68, v47
  s_cmp_eq_u32 s92, -1
  s_cselect_b64 s[98:99], -1, s[98:99]
  s_and_b64 vcc, s[72:73], s[96:97]
  v_cndmask_b32 v124, v46, v124, vcc
  s_and_b64 vcc, s[74:75], s[96:97]
  v_cndmask_b32 v125, v46, v125, vcc
  s_and_b64 vcc, s[76:77], s[96:97]
  v_cndmask_b32 v126, v46, v126, vcc
  s_and_b64 vcc, s[78:79], s[96:97]
  v_cndmask_b32 v127, v46, v127, vcc
  s_and_b64 vcc, s[72:73], s[98:99]
  v_cndmask_b32 v140, v46, v140, vcc
  s_and_b64 vcc, s[74:75], s[98:99]
  v_cndmask_b32 v141, v46, v141, vcc
  s_and_b64 vcc, s[76:77], s[98:99]
  v_cndmask_b32 v142, v46, v142, vcc
  s_and_b64 vcc, s[78:79], s[98:99]
  v_cndmask_b32 v143, v46, v143, vcc
B2_NM2:
  s_cmp_lt_i32 s67, 16
  s_cbranch_scc1 B2_DM3
  s_cmp_eq_u32 s51, 0
  s_cbranch_scc1 B2_NM3
  s_cmp_eq_u32 s93, -1
  s_cbranch_scc1 B2_NM3
B2_DM3:
  v_cmp_gt_i32 s[72:73], s67, v38
  v_cmp_gt_i32 s[74:75], s67, v39
  v_cmp_gt_i32 s[76:77], s67, v40
  v_cmp_gt_i32 s[78:79], s67, v41
  s_sub_u32 s68, s93, 0
  v_cmp_eq_u32 s[96:97], s68, v47
  s_cmp_eq_u32 s93, -1
  s_cselect_b64 s[96:97], -1, s[96:97]
  s_sub_u32 s68, s93, 4
  v_cmp_eq_u32 s[98:99], s68, v47
  s_cmp_eq_u32 s93, -1
  s_cselect_b64 s[98:99], -1, s[98:99]
  s_and_b64 vcc, s[72:73], s[96:97]
  v_cndmask_b32 v128, v46, v128, vcc
  s_and_b64 vcc, s[74:75], s[96:97]
  v_cndmask_b32 v129, v46, v129, vcc
  s_and_b64 vcc, s[76:77], s[96:97]
  v_cndmask_b32 v130, v46, v130, vcc
  s_and_b64 vcc, s[78:79], s[96:97]
  v_cndmask_b32 v131, v46, v131, vcc
  s_and_b64 vcc, s[72:73], s[98:99]
  v_cndmask_b32 v144, v46, v144, vcc
  s_and_b64 vcc, s[74:75], s[98:99]
  v_cndmask_b32 v145, v46, v145, vcc
  s_and_b64 vcc, s[76:77], s[98:99]
  v_cndmask_b32 v146, v46, v146, vcc
  s_and_b64 vcc, s[78:79], s[98:99]
  v_cndmask_b32 v147, v46, v147, vcc
B2_NM3:
  v_max3_f32 v53, v116, v117, v118
  v_max3_f32 v53, v53, v119, v120
  v_max3_f32 v53, v53, v121, v122
  v_max3_f32 v53, v53, v123, v124
  v_max3_f32 v53, v53, v125, v126
  v_max3_f32 v53, v53, v127, v128
  v_max3_f32 v53, v53, v129, v130
  v_max_f32 v53, v53, v131
  v_max3_f32 v55, v132, v133, v134
  v_max3_f32 v55, v55, v135, v136
  v_max3_f32 v55, v55, v137, v138
  v_max3_f32 v55, v55, v139, v140
  v_max3_f32 v55, v55, v141, v142
  v_max3_f32 v55, v55, v143, v144
  v_max3_f32 v55, v55, v145, v146
  v_max_f32 v55, v55, v147
  v_mov_b32 v54, v53
  v_mov_b32 v56, v55
  s_nop 1
  v_permlane16_swap_b32 v53, v54
  v_permlane16_swap_b32 v55, v56
  s_nop 0
  v_max_f32 v53, v53, v54
  v_max_f32 v55, v55, v56
  v_mov_b32 v54, v53
  v_mov_b32 v56, v55
  s_nop 1
  v_permlane32_swap_b32 v53, v54
  v_permlane32_swap_b32 v55, v56
  s_nop 0
  v_max_f32 v53, v53, v54
  v_max_f32 v55, v55, v56
  s_lshl_b32 s68, s3, 2
  v_add_u32 v2, s68, v36
  ds_write_b32 v2, v53 offset:0
  ds_write_b32 v2, v55 offset:512
  s_lshl_b32 s68, s3, 2
  v_add_u32 v5, s68, v199
  v_mov_b32 v4, s85
  ds_write_b32 v5, v4 offset:0
  s_add_u32 m0, s81, 0
  s_nop 0
  buffer_load_dwordx4 v20, s[28:31], s60 offen offset:0 nt lds
  buffer_load_dwordx4 v21, s[28:31], s60 offen offset:1024 nt lds
  buffer_load_dwordx4 v22, s[28:31], s60 offen offset:2048 nt lds
  buffer_load_dwordx4 v23, s[28:31], s60 offen offset:3072 nt lds
  s_add_u32 m0, s81, 4096
  s_nop 0
  buffer_load_dwordx4 v20, s[28:31], s61 offen offset:0 nt lds
  buffer_load_dwordx4 v21, s[28:31], s61 offen offset:1024 nt lds
  buffer_load_dwordx4 v22, s[28:31], s61 offen offset:2048 nt lds
  buffer_load_dwordx4 v23, s[28:31], s61 offen offset:3072 nt lds
  s_cmp_ge_u32 s3, 4
  s_cbranch_scc1 B2_V1
  s_add_u32 m0, s81, 8192
  s_nop 0
  buffer_load_dwordx4 v20, s[28:31], s62 offen offset:0 nt lds
  buffer_load_dwordx4 v21, s[28:31], s62 offen offset:1024 nt lds
  buffer_load_dwordx4 v22, s[28:31], s62 offen offset:2048 nt lds
  buffer_load_dwordx4 v23, s[28:31], s62 offen offset:3072 nt lds
  s_add_u32 m0, s81, 12288
  s_nop 0
  buffer_load_dwordx4 v20, s[28:31], s63 offen offset:0 nt lds
  buffer_load_dwordx4 v21, s[28:31], s63 offen offset:1024 nt lds
  buffer_load_dwordx4 v22, s[28:31], s63 offen offset:2048 nt lds
  buffer_load_dwordx4 v23, s[28:31], s63 offen offset:3072 nt lds
B2_V1:
  s_load_dword s58, s[20:21], 0
B2_PM:
  ds_read_b128 v[52:55], v199 offset:0
  ds_read_b128 v[56:59], v199 offset:16
  s_waitcnt lgkmcnt(0)
  v_min3_u32 v52, v52, v53, v54
  v_min3_u32 v55, v55, v56, v57
  v_min3_u32 v52, v52, v58, v59
  v_min_u32 v52, v52, v55
  v_cmp_gt_u32 vcc, s85, v52
  s_cbranch_vccnz B2_PM
  ds_read_b128 v[100:103], v36 offset:0
  ds_read_b128 v[104:107], v36 offset:16
  ds_read_b128 v[108:111], v36 offset:512
  ds_read_b128 v[112:115], v36 offset:528
  s_waitcnt lgkmcnt(0)
  v_max3_f32 v100, v100, v101, v102
  v_max3_f32 v103, v103, v104, v105
  v_max3_f32 v100, v100, v106, v107
  v_max_f32 v100, v100, v103
  v_mul_f32 v48, s80, v100
  v_max3_f32 v108, v108, v109, v110
  v_max3_f32 v111, v111, v112, v113
  v_max3_f32 v108, v108, v114, v115
  v_max_f32 v108, v108, v111
  v_mul_f32 v49, s80, v108
  v_fma_f32 v116, v116, s80, -v48
  v_fma_f32 v117, v117, s80, -v48
  v_fma_f32 v118, v118, s80, -v48
  v_fma_f32 v119, v119, s80, -v48
  v_fma_f32 v120, v120, s80, -v48
  v_fma_f32 v121, v121, s80, -v48
  v_fma_f32 v122, v122, s80, -v48
  v_fma_f32 v123, v123, s80, -v48
  v_fma_f32 v124, v124, s80, -v48
  v_fma_f32 v125, v125, s80, -v48
  v_fma_f32 v126, v126, s80, -v48
  v_fma_f32 v127, v127, s80, -v48
  v_fma_f32 v128, v128, s80, -v48
  v_fma_f32 v129, v129, s80, -v48
  v_fma_f32 v130, v130, s80, -v48
  v_fma_f32 v131, v131, s80, -v48
  v_exp_f32 v116, v116
  v_exp_f32 v117, v117
  v_exp_f32 v118, v118
  v_exp_f32 v119, v119
  v_exp_f32 v120, v120
  v_exp_f32 v121, v121
  v_exp_f32 v122, v122
  v_exp_f32 v123, v123
  v_exp_f32 v124, v124
  v_exp_f32 v125, v125
  v_exp_f32 v126, v126
  v_exp_f32 v127, v127
  v_exp_f32 v128, v128
  v_exp_f32 v129, v129
  v_exp_f32 v130, v130
  v_exp_f32 v131, v131
  v_fma_f32 v132, v132, s80, -v49
  v_fma_f32 v133, v133, s80, -v49
  v_fma_f32 v134, v134, s80, -v49
  v_fma_f32 v135, v135, s80, -v49
  v_fma_f32 v136, v136, s80, -v49
  v_fma_f32 v137, v137, s80, -v49
  v_fma_f32 v138, v138, s80, -v49
  v_fma_f32 v139, v139, s80, -v49
  v_fma_f32 v140, v140, s80, -v49
  v_fma_f32 v141, v141, s80, -v49
  v_fma_f32 v142, v142, s80, -v49
  v_fma_f32 v143, v143, s80, -v49
  v_fma_f32 v144, v144, s80, -v49
  v_fma_f32 v145, v145, s80, -v49
  v_fma_f32 v146, v146, s80, -v49
  v_fma_f32 v147, v147, s80, -v49
  v_exp_f32 v132, v132
  v_exp_f32 v133, v133
  v_exp_f32 v134, v134
  v_exp_f32 v135, v135
  v_exp_f32 v136, v136
  v_exp_f32 v137, v137
  v_exp_f32 v138, v138
  v_exp_f32 v139, v139
  v_exp_f32 v140, v140
  v_exp_f32 v141, v141
  v_exp_f32 v142, v142
  v_exp_f32 v143, v143
  v_exp_f32 v144, v144
  v_exp_f32 v145, v145
  v_exp_f32 v146, v146
  v_exp_f32 v147, v147
  s_nop 0
  v_cvt_pk_bf16_f32 v148, v116, v117
  v_cvt_pk_bf16_f32 v149, v118, v119
  v_cvt_pk_bf16_f32 v150, v120, v121
  v_cvt_pk_bf16_f32 v151, v122, v123
  v_cvt_pk_bf16_f32 v152, v124, v125
  v_cvt_pk_bf16_f32 v153, v126, v127
  v_cvt_pk_bf16_f32 v154, v128, v129
  v_cvt_pk_bf16_f32 v155, v130, v131
  v_cvt_pk_bf16_f32 v156, v132, v133
  v_cvt_pk_bf16_f32 v157, v134, v135
  v_cvt_pk_bf16_f32 v158, v136, v137
  v_cvt_pk_bf16_f32 v159, v138, v139
  v_cvt_pk_bf16_f32 v160, v140, v141
  v_cvt_pk_bf16_f32 v161, v142, v143
  v_cvt_pk_bf16_f32 v162, v144, v145
  v_cvt_pk_bf16_f32 v163, v146, v147
  ds_write_b64 v35, v[148:149] offset:0
  ds_write_b64 v35, v[156:157] offset:4096
  ds_write_b64 v35, v[150:151] offset:8192
  ds_write_b64 v35, v[158:159] offset:12288
  ds_write_b64 v35, v[152:153] offset:16384
  ds_write_b64 v35, v[160:161] offset:20480
  v_add_f32 v116, v116, v117
  v_add_f32 v118, v118, v119
  v_add_f32 v120, v120, v121
  v_add_f32 v122, v122, v123
  v_add_f32 v124, v124, v125
  v_add_f32 v126, v126, v127
  v_add_f32 v128, v128, v129
  v_add_f32 v130, v130, v131
  v_add_f32 v116, v116, v118
  v_add_f32 v120, v120, v122
  v_add_f32 v124, v124, v126
  v_add_f32 v128, v128, v130
  v_add_f32 v116, v116, v120
  v_add_f32 v124, v124, v128
  v_add_f32 v53, v116, v124
  v_add_f32 v132, v132, v133
  v_add_f32 v134, v134, v135
  v_add_f32 v136, v136, v137
  v_add_f32 v138, v138, v139
  v_add_f32 v140, v140, v141
  v_add_f32 v142, v142, v143
  v_add_f32 v144, v144, v145
  v_add_f32 v146, v146, v147
  v_add_f32 v132, v132, v134
  v_add_f32 v136, v136, v138
  v_add_f32 v140, v140, v142
  v_add_f32 v144, v144, v146
  v_add_f32 v132, v132, v136
  v_add_f32 v140, v140, v144
  v_add_f32 v55, v132, v140
  v_mov_b32 v54, v53
  v_mov_b32 v56, v55
  s_nop 1
  v_permlane16_swap_b32 v53, v54
  v_permlane16_swap_b32 v55, v56
  s_nop 0
  v_add_f32 v53, v53, v54
  v_add_f32 v55, v55, v56
  v_mov_b32 v54, v53
  v_mov_b32 v56, v55
  s_nop 1
  v_permlane32_swap_b32 v53, v54
  v_permlane32_swap_b32 v55, v56
  s_nop 0
  v_add_f32 v53, v53, v54
  v_add_f32 v55, v55, v56
  v_add_u32 v2, 1024, v2
  ds_write_b32 v2, v53 offset:0
  ds_write_b32 v2, v55 offset:512
  s_lshl_b32 s68, s3, 2
  v_add_u32 v5, s68, v199
  v_mov_b32 v4, s85
  ds_write_b32 v5, v4 offset:32
  s_cmp_lt_u32 s3, 4
  s_cbranch_scc1 B2_V2
  s_add_u32 m0, s81, 8192
  s_nop 0
  buffer_load_dwordx4 v20, s[28:31], s62 offen offset:0 nt lds
  buffer_load_dwordx4 v21, s[28:31], s62 offen offset:1024 nt lds
  buffer_load_dwordx4 v22, s[28:31], s62 offen offset:2048 nt lds
  buffer_load_dwordx4 v23, s[28:31], s62 offen offset:3072 nt lds
  s_add_u32 m0, s81, 12288
  s_nop 0
  buffer_load_dwordx4 v20, s[28:31], s63 offen offset:0 nt lds
  buffer_load_dwordx4 v21, s[28:31], s63 offen offset:1024 nt lds
  buffer_load_dwordx4 v22, s[28:31], s63 offen offset:2048 nt lds
  buffer_load_dwordx4 v23, s[28:31], s63 offen offset:3072 nt lds
B2_V2:
B2_PP:
  ds_read_b128 v[52:55], v199 offset:32
  ds_read_b128 v[56:59], v199 offset:48
  s_waitcnt lgkmcnt(0)
  v_min3_u32 v52, v52, v53, v54
  v_min3_u32 v55, v55, v56, v57
  v_min3_u32 v52, v52, v58, v59
  v_min_u32 v52, v52, v55
  v_cmp_gt_u32 vcc, s85, v52
  s_cbranch_vccnz B2_PP
  ds_read_b128 v[68:71], v34 offset:0
  ds_read_b128 v[72:75], v34 offset:4096
  ds_read_b128 v[76:79], v34 offset:1024
  ds_read_b128 v[80:83], v34 offset:5120
  ds_read_b128 v[84:87], v34 offset:2048
  ds_read_b128 v[88:91], v34 offset:6144
  ds_read_b128 v[92:95], v34 offset:3072
  ds_read_b128 v[96:99], v34 offset:7168
  s_waitcnt lgkmcnt(0)
  ds_read_b128 v[100:103], v34 offset:8192
  ds_read_b128 v[104:107], v34 offset:12288
  ds_read_b128 v[108:111], v34 offset:9216
  ds_read_b128 v[112:115], v34 offset:13312
  ds_read_b128 v[116:119], v34 offset:10240
  ds_read_b128 v[120:123], v34 offset:14336
  ds_read_b128 v[124:127], v34 offset:11264
  ds_read_b128 v[128:131], v34 offset:15360
  s_waitcnt lgkmcnt(0)
  ds_read_b128 v[132:135], v34 offset:16384
  ds_read_b128 v[136:139], v34 offset:20480
  ds_read_b128 v[140:143], v34 offset:17408
  ds_read_b128 v[144:147], v34 offset:21504
  ds_read_b128 v[180:183], v34 offset:18432
  ds_read_b128 v[184:187], v34 offset:22528
  ds_read_b128 v[216:219], v34 offset:19456
  ds_read_b128 v[220:223], v34 offset:23552
  s_waitcnt lgkmcnt(0)
  v_mov_b32 v197, s58
  v_cmp_eq_u32 vcc, 0, v197
  s_cbranch_vccz B2_NOK
  s_mov_b32 s88, 0
B2_NSPIN:
  global_load_dword v197, v198, s[20:21] sc1
  s_waitcnt vmcnt(0)
  s_add_u32 s88, s88, 1
  s_cmp_ge_u32 s88, 0x40000
  s_cbranch_scc1 B2_NOK
  v_cmp_eq_u32 vcc, 0, v197
  s_cbranch_vccnz B2_NSPIN
B2_NOK:
  v_mov_b32 v201, v197
  v_mov_b32 v203, v197
  v_mov_b32 v205, v197
  v_mov_b32 v207, v197
  v_mov_b32 v209, v197
  v_mov_b32 v211, v197
  v_mov_b32 v213, v197
  v_mov_b32 v215, v197
  s_waitcnt lgkmcnt(0)
  s_cmp_lg_u32 s3, 0
  s_cbranch_scc1 B2_NOMLP
  ds_read_b128 v[164:167], v36 offset:1024
  ds_read_b128 v[168:171], v36 offset:1040
  s_waitcnt lgkmcnt(0)
  v_add_f32 v164, v164, v168
  v_add_f32 v165, v165, v169
  v_add_f32 v166, v166, v170
  v_add_f32 v167, v167, v171
  v_add_f32 v164, v164, v165
  v_add_f32 v166, v166, v167
  v_add_f32 v58, v164, v166
  v_mov_b32 v56, v48
  v_mov_b32 v57, v197
  v_mov_b32 v59, v197
  ds_read_b128 v[164:167], v36 offset:1536
  ds_read_b128 v[168:171], v36 offset:1552
  s_waitcnt lgkmcnt(0)
  v_add_f32 v164, v164, v168
  v_add_f32 v165, v165, v169
  v_add_f32 v166, v166, v170
  v_add_f32 v167, v167, v171
  v_add_f32 v164, v164, v165
  v_add_f32 v166, v166, v167
  v_add_f32 v66, v164, v166
  v_mov_b32 v64, v49
  v_mov_b32 v65, v197
  v_mov_b32 v67, v197
B2_NOMLP:
  s_cmp_lg_u32 s3, 0
  s_cbranch_scc1 B2_NOML
  s_lshl_b32 s69, s43, 10
  s_add_u32 s69, s69, 0x400000
  s_mov_b64 exec, s[12:13]
  buffer_store_dwordx4 v[56:59], v62, s[36:39], s69 offen sc1
  s_add_u32 s69, s69, 32768
  s_mov_b64 exec, s[14:15]
  buffer_store_dwordx4 v[64:67], v63, s[36:39], s69 offen sc1
  s_mov_b64 exec, -1
B2_NOML:
  s_waitcnt vmcnt(12) lgkmcnt(0)
  s_barrier
  ds_read_b64_tr_b16 v[164:165], v32 offset:0
  ds_read_b64_tr_b16 v[166:167], v32 offset:16384
  ds_read_b64_tr_b16 v[168:169], v32 offset:32768
  ds_read_b64_tr_b16 v[170:171], v32 offset:49152
  ds_read_b64_tr_b16 v[172:173], v33 offset:0
  ds_read_b64_tr_b16 v[174:175], v33 offset:16384
  ds_read_b64_tr_b16 v[176:177], v33 offset:32768
  ds_read_b64_tr_b16 v[178:179], v33 offset:49152
  ds_write_b64 v35, v[154:155] offset:0
  ds_write_b64 v35, v[162:163] offset:4096
  s_waitcnt lgkmcnt(8)
  v_mfma_f32_16x16x32_bf16 v[188:191], v[68:71], v[164:167], 0
  v_mfma_f32_16x16x32_bf16 v[192:195], v[72:75], v[164:167], 0
  s_waitcnt lgkmcnt(6)
  v_mfma_f32_16x16x32_bf16 v[188:191], v[76:79], v[168:171], v[188:191]
  v_mfma_f32_16x16x32_bf16 v[192:195], v[80:83], v[168:171], v[192:195]
  s_waitcnt lgkmcnt(4)
  v_mfma_f32_16x16x32_bf16 v[188:191], v[84:87], v[172:175], v[188:191]
  v_mfma_f32_16x16x32_bf16 v[192:195], v[88:91], v[172:175], v[192:195]
  s_waitcnt lgkmcnt(2)
  v_mfma_f32_16x16x32_bf16 v[188:191], v[92:95], v[176:179], v[188:191]
  v_mfma_f32_16x16x32_bf16 v[192:195], v[96:99], v[176:179], v[192:195]
  s_waitcnt vmcnt(8) lgkmcnt(0)
  s_barrier
  ds_read_b64_tr_b16 v[164:165], v32 offset:4096
  ds_read_b64_tr_b16 v[166:167], v32 offset:20480
  ds_read_b64_tr_b16 v[168:169], v32 offset:36864
  ds_read_b64_tr_b16 v[170:171], v32 offset:53248
  ds_read_b64_tr_b16 v[172:173], v33 offset:4096
  ds_read_b64_tr_b16 v[174:175], v33 offset:20480
  ds_read_b64_tr_b16 v[176:177], v33 offset:36864
  ds_read_b64_tr_b16 v[178:179], v33 offset:53248
  s_waitcnt lgkmcnt(6)
  v_mfma_f32_16x16x32_bf16 v[188:191], v[100:103], v[164:167], v[188:191]
  v_mfma_f32_16x16x32_bf16 v[192:195], v[104:107], v[164:167], v[192:195]
  ds_read_b128 v[224:227], v34 offset:0
  ds_read_b128 v[228:231], v34 offset:4096
  ds_read_b128 v[232:235], v34 offset:1024
  ds_read_b128 v[236:239], v34 offset:5120
  ds_read_b128 v[240:243], v34 offset:2048
  ds_read_b128 v[244:247], v34 offset:6144
  ds_read_b128 v[248:251], v34 offset:3072
  ds_read_b128 v[252:255], v34 offset:7168
  s_waitcnt lgkmcnt(12)
  v_mfma_f32_16x16x32_bf16 v[188:191], v[108:111], v[168:171], v[188:191]
  v_mfma_f32_16x16x32_bf16 v[192:195], v[112:115], v[168:171], v[192:195]
  s_waitcnt lgkmcnt(10)
  v_mfma_f32_16x16x32_bf16 v[188:191], v[116:119], v[172:175], v[188:191]
  v_mfma_f32_16x16x32_bf16 v[192:195], v[120:123], v[172:175], v[192:195]
  s_waitcnt lgkmcnt(8)
  v_mfma_f32_16x16x32_bf16 v[188:191], v[124:127], v[176:179], v[188:191]
  v_mfma_f32_16x16x32_bf16 v[192:195], v[128:131], v[176:179], v[192:195]
  s_waitcnt vmcnt(4) lgkmcnt(0)
  s_barrier
  ds_read_b64_tr_b16 v[164:165], v32 offset:8192
  ds_read_b64_tr_b16 v[166:167], v32 offset:24576
  ds_read_b64_tr_b16 v[168:169], v32 offset:40960
  ds_read_b64_tr_b16 v[170:171], v32 offset:57344
  ds_read_b64_tr_b16 v[172:173], v33 offset:8192
  ds_read_b64_tr_b16 v[174:175], v33 offset:24576
  ds_read_b64_tr_b16 v[176:177], v33 offset:40960
  ds_read_b64_tr_b16 v[178:179], v33 offset:57344
  s_waitcnt lgkmcnt(6)
  v_mfma_f32_16x16x32_bf16 v[188:191], v[132:135], v[164:167], v[188:191]
  v_mfma_f32_16x16x32_bf16 v[192:195], v[136:139], v[164:167], v[192:195]
  s_waitcnt lgkmcnt(4)
  v_mfma_f32_16x16x32_bf16 v[188:191], v[140:143], v[168:171], v[188:191]
  v_mfma_f32_16x16x32_bf16 v[192:195], v[144:147], v[168:171], v[192:195]
  s_waitcnt lgkmcnt(2)
  v_mfma_f32_16x16x32_bf16 v[188:191], v[180:183], v[172:175], v[188:191]
  v_mfma_f32_16x16x32_bf16 v[192:195], v[184:187], v[172:175], v[192:195]
  s_waitcnt lgkmcnt(0)
  v_mfma_f32_16x16x32_bf16 v[188:191], v[216:219], v[176:179], v[188:191]
  v_mfma_f32_16x16x32_bf16 v[192:195], v[220:223], v[176:179], v[192:195]
  s_waitcnt vmcnt(0) lgkmcnt(0)
  s_barrier
  ds_read_b64_tr_b16 v[164:165], v32 offset:12288
  ds_read_b64_tr_b16 v[166:167], v32 offset:28672
  ds_read_b64_tr_b16 v[168:169], v32 offset:45056
  ds_read_b64_tr_b16 v[170:171], v32 offset:61440
  ds_read_b64_tr_b16 v[172:173], v33 offset:12288
  ds_read_b64_tr_b16 v[174:175], v33 offset:28672
  ds_read_b64_tr_b16 v[176:177], v33 offset:45056
  ds_read_b64_tr_b16 v[178:179], v33 offset:61440
  s_waitcnt lgkmcnt(6)
  v_mfma_f32_16x16x32_bf16 v[188:191], v[224:227], v[164:167], v[188:191]
  v_mfma_f32_16x16x32_bf16 v[192:195], v[228:231], v[164:167], v[192:195]
  s_waitcnt lgkmcnt(4)
  v_mfma_f32_16x16x32_bf16 v[188:191], v[232:235], v[168:171], v[188:191]
  v_mfma_f32_16x16x32_bf16 v[192:195], v[236:239], v[168:171], v[192:195]
  s_waitcnt lgkmcnt(2)
  v_mfma_f32_16x16x32_bf16 v[188:191], v[240:243], v[172:175], v[188:191]
  v_mfma_f32_16x16x32_bf16 v[192:195], v[244:247], v[172:175], v[192:195]
  s_waitcnt lgkmcnt(0)
  v_mfma_f32_16x16x32_bf16 v[188:191], v[248:251], v[176:179], v[188:191]
  v_mfma_f32_16x16x32_bf16 v[192:195], v[252:255], v[176:179], v[192:195]
  s_nop 7
  v_bfi_b32 v200, s87, v197, v188
  v_bfi_b32 v202, s87, v197, v189
  v_bfi_b32 v204, s87, v197, v190
  v_bfi_b32 v206, s87, v197, v191
  v_bfi_b32 v208, s87, v197, v192
  v_bfi_b32 v210, s87, v197, v193
  v_bfi_b32 v212, s87, v197, v194
  v_bfi_b32 v214, s87, v197, v195
  s_mov_b64 exec, s[8:9]
  buffer_store_dwordx4 v[200:203], v60, s[36:39], s16 offen sc1
  buffer_store_dwordx4 v[204:207], v60, s[36:39], s17 offen sc1
  s_mov_b64 exec, s[10:11]
  buffer_store_dwordx4 v[208:211], v61, s[36:39], s22 offen sc1
  buffer_store_dwordx4 v[212:215], v61, s[36:39], s23 offen sc1
  s_mov_b64 exec, -1
A_NEXT:
  s_add_u32 s42, s42, s48
  s_mul_i32 s68, s42, s45
  s_cmp_ge_u32 s68, s44
  s_cbranch_scc1 A_FIN
  s_waitcnt lgkmcnt(0)
  s_barrier
  s_setprio 3
  s_mov_b32 m0, s83
  s_nop 0
  buffer_load_dwordx4 v42, s[32:35], s84 offen lds
  s_branch A_ROUND
A_FIN0:
  v_cvt_f32_u32 v52, s45
  v_cmp_gt_u32 s[72:73], s47, v220
  v_rcp_f32 v52, v52
  v_cmp_lt_u32 s[74:75], s46, v219
  v_cmp_lt_u32 s[76:77], 0, v218
  v_cvt_f32_u32 v53, v220
  v_add_u32 v54, -1, v219
  v_cvt_f32_u32 v54, v54
  s_and_b32 s68, s72, s74
  s_and_b32 s68, s68, s76
  s_and_b32 s68, s68, 0x1ff
  v_mul_f32 v53, v53, v52
  v_mul_f32 v54, v54, v52
  v_add_f32 v53, 0x3ba3d70a, v53
  v_add_f32 v54, 0x3ba3d70a, v54
  v_cvt_u32_f32 v53, v53
  v_cvt_u32_f32 v54, v54
  s_bcnt1_i32_b32 s69, s68
  s_cmp_gt_u32 s69, 1
  s_cselect_b32 s51, 1, 0
  s_lshr_b32 s69, s68, 1
  v_readlane_b32 s49, v54, 0
  s_and_b32 s70, s69, 0xf
  s_cmp_eq_u32 s70, 0
  s_cselect_b32 s52, 1, 0
  s_lshr_b32 s71, s69, 4
  s_min_u32 s70, s70, 1
  s_min_u32 s71, s71, 1
  s_and_b32 s70, s70, s71
  s_and_b32 s71, s68, 1
  s_or_b32 s53, s70, s71
  s_cmp_lg_u32 s71, 0
  s_cselect_b32 s50, 0xff, s69
  s_add_u32 s49, s49, 1
  s_cmp_eq_u32 s41, 0
  s_cselect_b32 s49, 0, s49
  v_max_u32 v53, s49, v53
  v_add_u32 v54, 1, v54
  v_sub_u32 v54, v54, v53
  v_max_i32 v54, 0, v54
  v_cndmask_b32 v54, 0, v54, s[76:77]
  v_subrev_u32 v53, s49, v53
  v_add_u32 v54, s49, v54
  v_lshlrev_b32 v55, 2, v7
  v_add_u32 v55, 0x26800, v55
  ds_write_b32 v55, v53
  s_lshr_b32 s69, s101, 1
  s_and_b32 s69, s69, 7
  s_add_u32 s69, s69, 1
  v_readlane_b32 s86, v54, s69
  s_load_dword s58, s[20:21], 0
  s_waitcnt vmcnt(0) lgkmcnt(0)
  v_mov_b32 v197, s58
A_FIN:
  s_cmp_ge_u32 s101, 16
  s_cbranch_scc1 A_DONE
  v_cmp_eq_u32 vcc, 0, v197
  s_cbranch_vccz C_NOK
  s_mov_b32 s88, 0
C_NSPIN:
  global_load_dword v197, v198, s[20:21] sc1
  s_waitcnt vmcnt(0)
  s_add_u32 s88, s88, 1
  s_cmp_ge_u32 s88, 0x40000
  s_cbranch_scc1 C_NOK
  v_cmp_eq_u32 vcc, 0, v197
  s_cbranch_vccnz C_NSPIN
C_NOK:
  s_lshr_b32 s53, s101, 1
  s_lshl_b32 s53, s53, 3
  s_add_u32 s53, s53, s43
  s_and_b32 s59, s101, 1
  s_and_b32 s52, s3, 1
  s_lshr_b32 s54, s3, 1
  s_lshl_b32 s69, s53, 2
  s_lshl_b32 s71, s59, 1
  s_add_u32 s69, s69, s71
  s_lshl_b32 s69, s69, 8
  s_add_u32 s69, s69, 0x400000
  v_lshlrev_b32 v4, 4, v7
  buffer_load_dwordx4 v[164:167], v4, s[36:39], s69 offen sc1
  buffer_load_dwordx4 v[168:171], v4, s[36:39], s69 offen offset:256 sc1
  s_lshl_b32 s68, s53, 1
  s_add_u32 s68, s68, s59
  s_lshl_b32 s68, s68, 15
  s_lshl_b32 s71, s52, 10
  s_add_u32 s68, s68, s71
  s_lshl_b32 s71, s54, 11
  s_add_u32 s68, s68, s71
  v_lshlrev_b32 v3, 4, v1
  s_mov_b32 s89, 0
  s_add_u32 s55, s54, 0
  s_add_u32 s60, s68, 0
  s_cmp_lt_u32 s55, s86
  s_cselect_b32 s60, s60, 0x80000000
  s_cselect_b32 s71, 1, 0
  buffer_load_dwordx4 v[68:71], v3, s[36:39], s60 offen sc1
  s_or_b32 s89, s89, s71
  s_add_u32 s55, s54, 4
  s_add_u32 s61, s68, 8192
  s_cmp_lt_u32 s55, s86
  s_cselect_b32 s61, s61, 0x80000000
  s_cselect_b32 s71, 2, 0
  buffer_load_dwordx4 v[72:75], v3, s[36:39], s61 offen sc1
  s_or_b32 s89, s89, s71
  s_add_u32 s55, s54, 8
  s_add_u32 s62, s68, 16384
  s_cmp_lt_u32 s55, s86
  s_cselect_b32 s62, s62, 0x80000000
  s_cselect_b32 s71, 4, 0
  buffer_load_dwordx4 v[76:79], v3, s[36:39], s62 offen sc1
  s_or_b32 s89, s89, s71
  s_add_u32 s55, s54, 12
  s_add_u32 s63, s68, 24576
  s_cmp_lt_u32 s55, s86
  s_cselect_b32 s63, s63, 0x80000000
  s_cselect_b32 s71, 8, 0
  buffer_load_dwordx4 v[80:83], v3, s[36:39], s63 offen sc1
  s_or_b32 s89, s89, s71
  v_cmp_gt_u32 s[72:73], s86, v7
  s_mov_b32 s88, 0
  s_waitcnt vmcnt(4)
C_MLCHK:
  v_bitop3_b32 v54, v165, v167, v197 bitop3:0x7e
  v_bitop3_b32 v55, v169, v171, v197 bitop3:0x7e
  v_or_b32 v54, v54, v55
  v_cndmask_b32 v54, 0, v54, s[72:73]
  v_cmp_ne_u32 vcc, 0, v54
  s_cbranch_vccz C_MLOK
  s_add_u32 s88, s88, 1
  s_cmp_ge_u32 s88, 0x40000
  s_cbranch_scc1 C_RED
  s_sleep 2
  buffer_load_dwordx4 v[164:167], v4, s[36:39], s69 offen sc1
  buffer_load_dwordx4 v[168:171], v4, s[36:39], s69 offen offset:256 sc1
  s_waitcnt vmcnt(0)
  s_branch C_MLCHK
C_MLOK:
  v_cndmask_b32 v56, v46, v164, s[72:73]
  v_cndmask_b32 v58, v46, v168, s[72:73]
  v_cndmask_b32 v57, 0, v166, s[72:73]
  v_cndmask_b32 v59, 0, v170, s[72:73]
  v_mov_b32 v60, v56
  v_mov_b32 v61, v58
  s_nop 0
  v_max_f32_dpp v60, v60, v60 row_ror:8 row_mask:0xf bank_mask:0xf
  v_max_f32_dpp v61, v61, v61 row_ror:8 row_mask:0xf bank_mask:0xf
  s_nop 0
  v_max_f32_dpp v60, v60, v60 row_ror:4 row_mask:0xf bank_mask:0xf
  v_max_f32_dpp v61, v61, v61 row_ror:4 row_mask:0xf bank_mask:0xf
  s_nop 0
  v_max_f32_dpp v60, v60, v60 row_ror:2 row_mask:0xf bank_mask:0xf
  v_max_f32_dpp v61, v61, v61 row_ror:2 row_mask:0xf bank_mask:0xf
  s_nop 0
  v_max_f32_dpp v60, v60, v60 row_ror:1 row_mask:0xf bank_mask:0xf
  v_max_f32_dpp v61, v61, v61 row_ror:1 row_mask:0xf bank_mask:0xf
  v_sub_f32 v56, v56, v60
  v_sub_f32 v58, v58, v61
  v_exp_f32 v56, v56
  v_exp_f32 v58, v58
  s_nop 0
  v_mul_f32 v60, v56, v57
  v_mul_f32 v61, v58, v59
  s_nop 0
  v_add_f32_dpp v60, v60, v60 row_ror:8 row_mask:0xf bank_mask:0xf
  v_add_f32_dpp v61, v61, v61 row_ror:8 row_mask:0xf bank_mask:0xf
  s_nop 0
  v_add_f32_dpp v60, v60, v60 row_ror:4 row_mask:0xf bank_mask:0xf
  v_add_f32_dpp v61, v61, v61 row_ror:4 row_mask:0xf bank_mask:0xf
  s_nop 0
  v_add_f32_dpp v60, v60, v60 row_ror:2 row_mask:0xf bank_mask:0xf
  v_add_f32_dpp v61, v61, v61 row_ror:2 row_mask:0xf bank_mask:0xf
  s_nop 0
  v_add_f32_dpp v60, v60, v60 row_ror:1 row_mask:0xf bank_mask:0xf
  v_add_f32_dpp v61, v61, v61 row_ror:1 row_mask:0xf bank_mask:0xf
  v_rcp_f32 v60, v60
  v_rcp_f32 v61, v61
  v_mov_b32 v62, 0
  v_mov_b32 v63, 0
  v_mul_f32 v56, v56, v60
  v_mul_f32 v58, v58, v61
  s_nop 0
  s_add_u32 s55, s54, 0
  v_readlane_b32 s64, v56, s55
  v_readlane_b32 s90, v58, s55
  s_add_u32 s55, s54, 4
  v_readlane_b32 s65, v56, s55
  v_readlane_b32 s91, v58, s55
  s_add_u32 s55, s54, 8
  v_readlane_b32 s66, v56, s55
  v_readlane_b32 s92, v58, s55
  s_add_u32 s55, s54, 12
  v_readlane_b32 s67, v56, s55
  v_readlane_b32 s93, v58, s55
  s_waitcnt vmcnt(0)
  s_bitcmp1_b32 s89, 0
  s_cbranch_scc0 C_A0
  v_bitop3_b32 v54, v69, v71, v197 bitop3:0x7e
  v_bitop3_b32 v55, v68, v70, v197 bitop3:0x7e
  v_and_or_b32 v54, v55, s87, v54
  v_cmp_ne_u32 vcc, 0, v54
  s_cbranch_vccnz C_A0
  v_fmac_f32 v62, s64, v68
  v_fmac_f32 v63, s90, v70
  s_bitset0_b32 s89, 0
C_A0:
  s_bitcmp1_b32 s89, 1
  s_cbranch_scc0 C_A1
  v_bitop3_b32 v54, v73, v75, v197 bitop3:0x7e
  v_bitop3_b32 v55, v72, v74, v197 bitop3:0x7e
  v_and_or_b32 v54, v55, s87, v54
  v_cmp_ne_u32 vcc, 0, v54
  s_cbranch_vccnz C_A1
  v_fmac_f32 v62, s65, v72
  v_fmac_f32 v63, s91, v74
  s_bitset0_b32 s89, 1
C_A1:
  s_bitcmp1_b32 s89, 2
  s_cbranch_scc0 C_A2
  v_bitop3_b32 v54, v77, v79, v197 bitop3:0x7e
  v_bitop3_b32 v55, v76, v78, v197 bitop3:0x7e
  v_and_or_b32 v54, v55, s87, v54
  v_cmp_ne_u32 vcc, 0, v54
  s_cbranch_vccnz C_A2
  v_fmac_f32 v62, s66, v76
  v_fmac_f32 v63, s92, v78
  s_bitset0_b32 s89, 2
C_A2:
  s_bitcmp1_b32 s89, 3
  s_cbranch_scc0 C_A3
  v_bitop3_b32 v54, v81, v83, v197 bitop3:0x7e
  v_bitop3_b32 v55, v80, v82, v197 bitop3:0x7e
  v_and_or_b32 v54, v55, s87, v54
  v_cmp_ne_u32 vcc, 0, v54
  s_cbranch_vccnz C_A3
  v_fmac_f32 v62, s67, v80
  v_fmac_f32 v63, s93, v82
  s_bitset0_b32 s89, 3
C_A3:
  s_cmp_eq_u32 s89, 0
  s_cbranch_scc1 C_RED
  s_bitcmp1_b32 s89, 0
  s_cselect_b32 s71, s60, 0x80000000
  buffer_load_dwordx4 v[68:71], v3, s[36:39], s71 offen sc1
  s_bitcmp1_b32 s89, 1
  s_cselect_b32 s71, s61, 0x80000000
  buffer_load_dwordx4 v[72:75], v3, s[36:39], s71 offen sc1
  s_bitcmp1_b32 s89, 2
  s_cselect_b32 s71, s62, 0x80000000
  buffer_load_dwordx4 v[76:79], v3, s[36:39], s71 offen sc1
  s_bitcmp1_b32 s89, 3
  s_cselect_b32 s71, s63, 0x80000000
  buffer_load_dwordx4 v[80:83], v3, s[36:39], s71 offen sc1
C_LOOP:
  s_sleep 1
  s_bitcmp1_b32 s89, 0
  s_cselect_b32 s71, s60, 0x80000000
  buffer_load_dwordx4 v[84:87], v3, s[36:39], s71 offen sc1
  s_bitcmp1_b32 s89, 1
  s_cselect_b32 s71, s61, 0x80000000
  buffer_load_dwordx4 v[88:91], v3, s[36:39], s71 offen sc1
  s_bitcmp1_b32 s89, 2
  s_cselect_b32 s71, s62, 0x80000000
  buffer_load_dwordx4 v[92:95], v3, s[36:39], s71 offen sc1
  s_bitcmp1_b32 s89, 3
  s_cselect_b32 s71, s63, 0x80000000
  buffer_load_dwordx4 v[96:99], v3, s[36:39], s71 offen sc1
  s_waitcnt vmcnt(4)
  s_bitcmp1_b32 s89, 0
  s_cbranch_scc0 C_B0
  v_bitop3_b32 v54, v69, v71, v197 bitop3:0x7e
  v_bitop3_b32 v55, v68, v70, v197 bitop3:0x7e
  v_and_or_b32 v54, v55, s87, v54
  v_cmp_ne_u32 vcc, 0, v54
  s_cbranch_vccnz C_B0
  v_fmac_f32 v62, s64, v68
  v_fmac_f32 v63, s90, v70
  s_bitset0_b32 s89, 0
C_B0:
  s_bitcmp1_b32 s89, 1
  s_cbranch_scc0 C_B1
  v_bitop3_b32 v54, v73, v75, v197 bitop3:0x7e
  v_bitop3_b32 v55, v72, v74, v197 bitop3:0x7e
  v_and_or_b32 v54, v55, s87, v54
  v_cmp_ne_u32 vcc, 0, v54
  s_cbranch_vccnz C_B1
  v_fmac_f32 v62, s65, v72
  v_fmac_f32 v63, s91, v74
  s_bitset0_b32 s89, 1
C_B1:
  s_bitcmp1_b32 s89, 2
  s_cbranch_scc0 C_B2
  v_bitop3_b32 v54, v77, v79, v197 bitop3:0x7e
  v_bitop3_b32 v55, v76, v78, v197 bitop3:0x7e
  v_and_or_b32 v54, v55, s87, v54
  v_cmp_ne_u32 vcc, 0, v54
  s_cbranch_vccnz C_B2
  v_fmac_f32 v62, s66, v76
  v_fmac_f32 v63, s92, v78
  s_bitset0_b32 s89, 2
C_B2:
  s_bitcmp1_b32 s89, 3
  s_cbranch_scc0 C_B3
  v_bitop3_b32 v54, v81, v83, v197 bitop3:0x7e
  v_bitop3_b32 v55, v80, v82, v197 bitop3:0x7e
  v_and_or_b32 v54, v55, s87, v54
  v_cmp_ne_u32 vcc, 0, v54
  s_cbranch_vccnz C_B3
  v_fmac_f32 v62, s67, v80
  v_fmac_f32 v63, s93, v82
  s_bitset0_b32 s89, 3
C_B3:
  s_cmp_eq_u32 s89, 0
  s_cbranch_scc1 C_RED
  s_sleep 1
  s_bitcmp1_b32 s89, 0
  s_cselect_b32 s71, s60, 0x80000000
  buffer_load_dwordx4 v[68:71], v3, s[36:39], s71 offen sc1
  s_bitcmp1_b32 s89, 1
  s_cselect_b32 s71, s61, 0x80000000
  buffer_load_dwordx4 v[72:75], v3, s[36:39], s71 offen sc1
  s_bitcmp1_b32 s89, 2
  s_cselect_b32 s71, s62, 0x80000000
  buffer_load_dwordx4 v[76:79], v3, s[36:39], s71 offen sc1
  s_bitcmp1_b32 s89, 3
  s_cselect_b32 s71, s63, 0x80000000
  buffer_load_dwordx4 v[80:83], v3, s[36:39], s71 offen sc1
  s_waitcnt vmcnt(4)
  s_bitcmp1_b32 s89, 0
  s_cbranch_scc0 C_C0
  v_bitop3_b32 v54, v85, v87, v197 bitop3:0x7e
  v_bitop3_b32 v55, v84, v86, v197 bitop3:0x7e
  v_and_or_b32 v54, v55, s87, v54
  v_cmp_ne_u32 vcc, 0, v54
  s_cbranch_vccnz C_C0
  v_fmac_f32 v62, s64, v84
  v_fmac_f32 v63, s90, v86
  s_bitset0_b32 s89, 0
C_C0:
  s_bitcmp1_b32 s89, 1
  s_cbranch_scc0 C_C1
  v_bitop3_b32 v54, v89, v91, v197 bitop3:0x7e
  v_bitop3_b32 v55, v88, v90, v197 bitop3:0x7e
  v_and_or_b32 v54, v55, s87, v54
  v_cmp_ne_u32 vcc, 0, v54
  s_cbranch_vccnz C_C1
  v_fmac_f32 v62, s65, v88
  v_fmac_f32 v63, s91, v90
  s_bitset0_b32 s89, 1
C_C1:
  s_bitcmp1_b32 s89, 2
  s_cbranch_scc0 C_C2
  v_bitop3_b32 v54, v93, v95, v197 bitop3:0x7e
  v_bitop3_b32 v55, v92, v94, v197 bitop3:0x7e
  v_and_or_b32 v54, v55, s87, v54
  v_cmp_ne_u32 vcc, 0, v54
  s_cbranch_vccnz C_C2
  v_fmac_f32 v62, s66, v92
  v_fmac_f32 v63, s92, v94
  s_bitset0_b32 s89, 2
C_C2:
  s_bitcmp1_b32 s89, 3
  s_cbranch_scc0 C_C3
  v_bitop3_b32 v54, v97, v99, v197 bitop3:0x7e
  v_bitop3_b32 v55, v96, v98, v197 bitop3:0x7e
  v_and_or_b32 v54, v55, s87, v54
  v_cmp_ne_u32 vcc, 0, v54
  s_cbranch_vccnz C_C3
  v_fmac_f32 v62, s67, v96
  v_fmac_f32 v63, s93, v98
  s_bitset0_b32 s89, 3
C_C3:
  s_add_u32 s88, s88, 1
  s_cmp_ge_u32 s88, 0x40000
  s_cbranch_scc1 C_RED
  s_cmp_lg_u32 s89, 0
  s_cbranch_scc1 C_LOOP
C_RED:
  v_lshlrev_b32 v2, 3, v0
  ds_write_b64 v2, v[62:63]
  s_lshl_b32 s68, s53, 1
  s_add_u32 s68, s68, s59
  s_lshl_b32 s68, s68, 9
  s_lshl_b32 s69, s52, 7
  s_add_u32 s68, s68, s69
  v_lshlrev_b32 v3, 1, v1
  s_mov_b32 s32, s18
  s_and_b32 s33, s19, 0xffff
  s_waitcnt lgkmcnt(0)
  s_barrier
  s_cmp_ge_u32 s3, 2
  s_cbranch_scc1 A_DONE
  ds_read_b64 v[172:173], v2 offset:1024
  ds_read_b64 v[174:175], v2 offset:2048
  ds_read_b64 v[176:177], v2 offset:3072
  s_waitcnt lgkmcnt(0)
  v_add_f32 v62, v62, v172
  v_add_f32 v63, v63, v173
  v_add_f32 v174, v174, v176
  v_add_f32 v175, v175, v177
  v_add_f32 v62, v62, v174
  v_add_f32 v63, v63, v175
  v_cvt_pk_bf16_f32 v62, v62, v63
  buffer_store_short v62, v3, s[32:35], s68 offen
  buffer_store_short_d16_hi v62, v3, s[32:35], s68 offen offset:256
A_DONE:
A_END:
  s_endpgm
.section .rodata,"a"
.p2align 6
.amdhsa_kernel standalone__paged_block_table_kv_radixattention__decode_kernel
  .amdhsa_next_free_vgpr 256
  .amdhsa_next_free_sgpr 102
  .amdhsa_accum_offset 256
  .amdhsa_group_segment_fixed_size 0
  .amdhsa_kernarg_size 64
  .amdhsa_user_sgpr_count 2
  .amdhsa_user_sgpr_kernarg_segment_ptr 1
  .amdhsa_system_sgpr_workgroup_id_x 1
.end_amdhsa_kernel
```
